```python
import torch

def _softmax(x, axis=-1):
    return torch.softmax(x, dim=axis)
def _gelu(x):
    return torch.nn.functional.gelu(x, approximate="tanh")
def _silu(x):
    return torch.nn.functional.silu(x)
def _sigmoid(x):
    return torch.sigmoid(x)
def _layernorm(x, axis=-1, eps=1e-5):
    m = x.mean(dim=axis, keepdim=True)
    v = x.var(dim=axis, keepdim=True, unbiased=False)
    return (x - m) / torch.sqrt(v + eps)
def _scatter_add(tgt, idx, src, axis=0):
    return tgt.clone().index_add_(axis, idx, src)
def _segment_sum(src, seg, n):
    out = torch.zeros((n,) + src.shape[1:], dtype=src.dtype)
    return out.index_add_(0, seg, src)
def _pad(x, pw):
    flat = tuple(v for pair in reversed(pw) for v in pair)
    return torch.nn.functional.pad(x, flat)

kernel_name = 'sequential_preLN__linear_kernel_hedgehog__dense_activation_gelu__prompt'

def setup_inputs():

    _w = (lambda a: (lambda t: t.to(torch.bfloat16) if t.is_floating_point() else t)(torch.as_tensor(a)))
    def _A_setup():
        B, S, D, H = 1, 2048, 576, 32
        Dh = D // H
        return {
            "x": _w((lambda *s: torch.randn(*s, dtype=torch.bfloat16) * 0.05)(B, S, D)),
            "wqkv": _w((lambda *s: torch.randn(*s, dtype=torch.bfloat16) * 0.2)(D, 3 * D)),
            "w_phi": _w((lambda *s: torch.randn(*s, dtype=torch.bfloat16) * 0.2)(H, Dh, Dh) * (Dh ** -0.5)),
            "wo": _w((lambda *s: torch.randn(*s, dtype=torch.bfloat16) * 0.05)(D, D)),
        }
    _A_in = _A_setup()

    def _B_setup():
        B, S, D, F = 1, 2048, 576, 4608
        return {
            "x": _w((lambda *s: torch.randn(*s, dtype=torch.bfloat16) * 0.05)(B, S, D)),
            "w1": _w((lambda *s: torch.randn(*s, dtype=torch.bfloat16) * 3.2)(D, F) * (D ** -0.5)),
            "b1": _w((lambda *s: torch.randn(*s, dtype=torch.bfloat16) * 0.1)(F) * 0.01),
            "w2": _w((lambda *s: torch.randn(*s, dtype=torch.bfloat16) * 0.1)(F, D) * (F ** -0.5)),
            "b2": _w((lambda *s: torch.randn(*s, dtype=torch.bfloat16) * 0.1)(D) * 0.01),
        }
    _B_in = _B_setup()

    return {
        "A_x": _A_in["x"],
        "A_wqkv": _A_in["wqkv"],
        "A_w_phi": _A_in["w_phi"],
        "A_wo": _A_in["wo"],
        "B_x": _B_in["x"],
        "B_w1": _B_in["w1"],
        "B_b1": _B_in["b1"],
        "B_w2": _B_in["w2"],
        "B_b2": _B_in["b2"],
    }

def reference(A_x, A_wqkv, A_w_phi, A_wo, B_x, B_w1, B_b1, B_w2, B_b2):
    def _A_ref(x, wqkv, w_phi, wo):
        B, S, D = x.shape
        H = 32; Dh = D // H
        qkv = (lambda x, *d: x.permute(*d))((x @ wqkv).reshape(B, S, 3, H, Dh), 2, 0, 3, 1, 4)
        q, k, v = qkv[0], qkv[1], qkv[2]
        pq = torch.einsum("bhsd,hdf->bhsf", q, w_phi)
        pk = torch.einsum("bhsd,hdf->bhsf", k, w_phi)
        phi_q = torch.concatenate([_softmax(pq, axis=-1), _softmax(-pq, axis=-1)], axis=-1)
        phi_k = torch.concatenate([_softmax(pk, axis=-1), _softmax(-pk, axis=-1)], axis=-1)
        kv = torch.einsum("bhsf,bhsd->bhfd", phi_k, v)
        z  = torch.einsum("bhsf->bhf", phi_k)
        num = torch.einsum("bhqf,bhfd->bhqd", phi_q, kv)
        den = torch.einsum("bhqf,bhf->bhq", phi_q, z)[..., None] + 1e-6
        o = num / den
        return (lambda x, *d: x.permute(*d))(o, 0, 2, 1, 3).reshape(B, S, D) @ wo

    def _B_ref(x, w1, b1, w2, b2):
        h = torch.einsum("bsd,df->bsf", x, w1) + b1
        h = _gelu(h)
        return torch.einsum("bsf,fd->bsd", h, w2) + b2

    x = A_x
    h = x + _A_ref(_layernorm(x, axis=-1), A_wqkv, A_w_phi, A_wo)
    h2 = h + _B_ref(_layernorm(h, axis=-1), B_w1, B_b1, B_w2, B_b2)
    return h2
```

```asm
; @launch kernel=p1_kernel grid=(256,1,1) block=(512,1,1) lds=156672
; @launch kernel=p2_kernel grid=(256,1,1) block=(256,1,1) lds=36864
; @launch kernel=ffn_kernel grid=(256,1,1) block=(256,1,1) lds=73728
; @launch kernel=red_kernel grid=(256,1,1) block=(192,1,1) lds=0
.amdgcn_target "amdgcn-amd-amdhsa--gfx950"
.text
.globl p1_kernel
.p2align 8
.type p1_kernel,@function
p1_kernel:
  s_cmp_ge_u32 s2, 256
  s_cbranch_scc1 p1_kernel_end
  s_load_dwordx8 s[24:31], s[0:1], 0
  v_and_b32 v1, 63, v0
  v_lshrrev_b32 v13, 6, v0
  s_nop 0
  v_readfirstlane_b32 s40, v13
  s_and_b32 s3, s40, 3
  s_and_b32 s62, s2, 7
  s_lshr_b32 s63, s2, 3
  s_and_b32 s64, s62, 3
  s_lshl_b32 s64, s64, 2
  s_and_b32 s65, s63, 3
  s_add_u32 s41, s64, s65
  s_lshr_b32 s64, s62, 2
  s_lshl_b32 s64, s64, 3
  s_lshr_b32 s65, s63, 2
  s_add_u32 s42, s64, s65
  s_lshl_b32 s43, s42, 2
  s_add_u32 s43, s43, s3
  s_mul_i32 s64, s41, 72
  s_and_b32 s65, s64, 0xffffffc0
  s_sub_u32 s51, s64, s65
  s_mov_b32 s61, 0x7fff0000
  s_cmp_ge_u32 s40, 4
  s_cbranch_scc0 p1_kernel_C
  v_lshrrev_b32 v13, 3, v1
  v_and_b32 v14, 7, v1
  v_lshrrev_b32 v16, 1, v13
  v_xor_b32 v14, v14, v16
  v_mul_u32_u24 v13, 1152, v13
  v_lshl_add_u32 v32, v14, 4, v13
  v_xor_b32 v14, 4, v14
  v_lshl_add_u32 v33, v14, 4, v13
  v_add_u32 v34, 18432, v32
  v_add_u32 v33, 9216, v33
  v_add_u32 v35, 18432, v33
  s_mul_i32 s45, s43, 36864
  s_lshl_b32 s62, s3, 4
  s_mul_i32 s62, s62, 3456
  s_add_u32 s46, s62, s65
  s_lshl_b32 s47, s3, 12
  s_add_u32 s54, s47, 49152
  s_mul_i32 s48, s3, 6144
  s_add_u32 s48, s48, 49152
  s_add_u32 s55, s48, 98304
  s_mov_b32 s49, 0
  s_add_u32 s53, s45, 1152
  s_add_u32 s60, s46, 1990656
  s_lshr_b32 s62, s2, 3
  s_mul_i32 s63, s62, 7282
  s_lshr_b32 s63, s63, 16
  s_mul_i32 s63, s63, 9
  s_sub_u32 s62, s62, s63
  s_lshl_b32 s63, s62, 7
  s_add_u32 s45, s45, s63
  s_mul_i32 s63, s62, 221184
  s_add_u32 s46, s46, s63
  v_lshrrev_b32 v16, 2, v1
  v_and_b32 v17, 3, v1
  s_mov_b32 s50, 0
  s_waitcnt lgkmcnt(0)
  s_load_dwordx8 s[32:39], s[0:1], 32
  s_load_dwordx4 s[4:7], s[0:1], 80
  s_mov_b32 s8, s24
  s_and_b32 s9, s25, 0xffff
  s_mov_b32 s10, 2359296
  s_mov_b32 s11, 0x20000
  s_mov_b32 s12, s26
  s_and_b32 s13, s27, 0xffff
  s_mov_b32 s14, 1990656
  s_mov_b32 s15, 0x20000
  s_add_u32 m0, s47, 0
  s_nop 0
  buffer_load_dwordx4 v32, s[8:11], s45 offen lds
  s_add_u32 m0, s47, 1024
  s_nop 0
  buffer_load_dwordx4 v33, s[8:11], s45 offen lds
  s_add_u32 m0, s47, 2048
  s_nop 0
  buffer_load_dwordx4 v34, s[8:11], s45 offen lds
  s_add_u32 m0, s47, 3072
  s_nop 0
  buffer_load_dwordx4 v35, s[8:11], s45 offen lds
  v_add_u32 v18, 0, v16
  v_mul_u32_u24 v19, 43, v18
  v_lshrrev_b32 v19, 8, v19
  v_mul_u32_u24 v20, 6, v19
  v_sub_u32 v20, v18, v20
  v_lshrrev_b32 v21, 1, v19
  v_and_b32 v21, 1, v21
  v_add_u32 v22, 6, v20
  v_sub_u32 v22, v22, v21
  v_cmp_le_u32 vcc, 6, v22
  v_subrev_u32 v23, 6, v22
  s_nop 0
  v_cndmask_b32 v22, v22, v23, vcc
  v_lshrrev_b32 v23, 1, v22
  v_and_b32 v22, 1, v22
  v_lshrrev_b32 v24, 1, v23
  v_xor_b32 v24, v24, v17
  v_mul_u32_u24 v19, 3456, v19
  v_mul_u32_u24 v23, 1152, v23
  v_lshlrev_b32 v22, 6, v22
  v_lshlrev_b32 v24, 4, v24
  v_add3_u32 v19, v19, v23, v22
  v_add_u32 v36, v19, v24
  s_add_u32 m0, s48, 0
  s_nop 0
  buffer_load_dwordx4 v36, s[12:15], s46 offen lds
  v_add_u32 v18, 16, v16
  v_mul_u32_u24 v19, 43, v18
  v_lshrrev_b32 v19, 8, v19
  v_mul_u32_u24 v20, 6, v19
  v_sub_u32 v20, v18, v20
  v_lshrrev_b32 v21, 1, v19
  v_and_b32 v21, 1, v21
  v_add_u32 v22, 6, v20
  v_sub_u32 v22, v22, v21
  v_cmp_le_u32 vcc, 6, v22
  v_subrev_u32 v23, 6, v22
  s_nop 0
  v_cndmask_b32 v22, v22, v23, vcc
  v_lshrrev_b32 v23, 1, v22
  v_and_b32 v22, 1, v22
  v_lshrrev_b32 v24, 1, v23
  v_xor_b32 v24, v24, v17
  v_mul_u32_u24 v19, 3456, v19
  v_mul_u32_u24 v23, 1152, v23
  v_lshlrev_b32 v22, 6, v22
  v_lshlrev_b32 v24, 4, v24
  v_add3_u32 v19, v19, v23, v22
  v_add_u32 v37, v19, v24
  s_add_u32 m0, s48, 1024
  s_nop 0
  buffer_load_dwordx4 v37, s[12:15], s46 offen lds
  v_add_u32 v18, 32, v16
  v_mul_u32_u24 v19, 43, v18
  v_lshrrev_b32 v19, 8, v19
  v_mul_u32_u24 v20, 6, v19
  v_sub_u32 v20, v18, v20
  v_lshrrev_b32 v21, 1, v19
  v_and_b32 v21, 1, v21
  v_add_u32 v22, 6, v20
  v_sub_u32 v22, v22, v21
  v_cmp_le_u32 vcc, 6, v22
  v_subrev_u32 v23, 6, v22
  s_nop 0
  v_cndmask_b32 v22, v22, v23, vcc
  v_lshrrev_b32 v23, 1, v22
  v_and_b32 v22, 1, v22
  v_lshrrev_b32 v24, 1, v23
  v_xor_b32 v24, v24, v17
  v_mul_u32_u24 v19, 3456, v19
  v_mul_u32_u24 v23, 1152, v23
  v_lshlrev_b32 v22, 6, v22
  v_lshlrev_b32 v24, 4, v24
  v_add3_u32 v19, v19, v23, v22
  v_add_u32 v38, v19, v24
  s_add_u32 m0, s48, 2048
  s_nop 0
  buffer_load_dwordx4 v38, s[12:15], s46 offen lds
  v_add_u32 v18, 48, v16
  v_mul_u32_u24 v19, 43, v18
  v_lshrrev_b32 v19, 8, v19
  v_mul_u32_u24 v20, 6, v19
  v_sub_u32 v20, v18, v20
  v_lshrrev_b32 v21, 1, v19
  v_and_b32 v21, 1, v21
  v_add_u32 v22, 6, v20
  v_sub_u32 v22, v22, v21
  v_cmp_le_u32 vcc, 6, v22
  v_subrev_u32 v23, 6, v22
  s_nop 0
  v_cndmask_b32 v22, v22, v23, vcc
  v_lshrrev_b32 v23, 1, v22
  v_and_b32 v22, 1, v22
  v_lshrrev_b32 v24, 1, v23
  v_xor_b32 v24, v24, v17
  v_mul_u32_u24 v19, 3456, v19
  v_mul_u32_u24 v23, 1152, v23
  v_lshlrev_b32 v22, 6, v22
  v_lshlrev_b32 v24, 4, v24
  v_add3_u32 v19, v19, v23, v22
  v_add_u32 v39, v19, v24
  s_add_u32 m0, s48, 3072
  s_nop 0
  buffer_load_dwordx4 v39, s[12:15], s46 offen lds
  v_add_u32 v18, 64, v16
  v_mul_u32_u24 v19, 43, v18
  v_lshrrev_b32 v19, 8, v19
  v_mul_u32_u24 v20, 6, v19
  v_sub_u32 v20, v18, v20
  v_lshrrev_b32 v21, 1, v19
  v_and_b32 v21, 1, v21
  v_add_u32 v22, 6, v20
  v_sub_u32 v22, v22, v21
  v_cmp_le_u32 vcc, 6, v22
  v_subrev_u32 v23, 6, v22
  s_nop 0
  v_cndmask_b32 v22, v22, v23, vcc
  v_lshrrev_b32 v23, 1, v22
  v_and_b32 v22, 1, v22
  v_lshrrev_b32 v24, 1, v23
  v_xor_b32 v24, v24, v17
  v_mul_u32_u24 v19, 3456, v19
  v_mul_u32_u24 v23, 1152, v23
  v_lshlrev_b32 v22, 6, v22
  v_lshlrev_b32 v24, 4, v24
  v_add3_u32 v19, v19, v23, v22
  v_add_u32 v40, v19, v24
  s_add_u32 m0, s48, 4096
  s_nop 0
  buffer_load_dwordx4 v40, s[12:15], s46 offen lds
  v_add_u32 v18, 80, v16
  v_mul_u32_u24 v19, 43, v18
  v_lshrrev_b32 v19, 8, v19
  v_mul_u32_u24 v20, 6, v19
  v_sub_u32 v20, v18, v20
  v_lshrrev_b32 v21, 1, v19
  v_and_b32 v21, 1, v21
  v_add_u32 v22, 6, v20
  v_sub_u32 v22, v22, v21
  v_cmp_le_u32 vcc, 6, v22
  v_subrev_u32 v23, 6, v22
  s_nop 0
  v_cndmask_b32 v22, v22, v23, vcc
  v_lshrrev_b32 v23, 1, v22
  v_and_b32 v22, 1, v22
  v_lshrrev_b32 v24, 1, v23
  v_xor_b32 v24, v24, v17
  v_mul_u32_u24 v19, 3456, v19
  v_mul_u32_u24 v23, 1152, v23
  v_lshlrev_b32 v22, 6, v22
  v_lshlrev_b32 v24, 4, v24
  v_add3_u32 v19, v19, v23, v22
  v_add_u32 v41, v19, v24
  s_add_u32 m0, s48, 5120
  s_nop 0
  buffer_load_dwordx4 v41, s[12:15], s46 offen lds
  s_add_u32 s45, s45, 128
  s_cmp_eq_u32 s45, s53
  s_cselect_b32 s62, 1152, 0
  s_sub_u32 s45, s45, s62
  s_add_u32 s47, s47, 16384
  s_cmp_eq_u32 s47, s54
  s_cselect_b32 s62, 49152, 0
  s_sub_u32 s47, s47, s62
  s_add_u32 s49, s49, 1
  s_cmp_ge_u32 s49, 9
  s_cselect_b32 s45, s61, s45
  s_add_u32 s46, s46, 221184
  s_cmp_eq_u32 s46, s60
  s_cselect_b32 s62, 1990656, 0
  s_sub_u32 s46, s46, s62
  s_add_u32 s48, s48, 24576
  s_cmp_eq_u32 s48, s55
  s_cselect_b32 s62, 98304, 0
  s_sub_u32 s48, s48, s62
  s_add_u32 s50, s50, 1
  s_cmp_ge_u32 s50, 9
  s_cselect_b32 s46, s61, s46
  s_waitcnt lgkmcnt(0)
  s_mov_b32 s20, s6
  s_and_b32 s21, s7, 0xffff
  s_mov_b32 s22, 39313408
  s_mov_b32 s23, 0x20000
  s_mov_b32 s62, s30
  s_mov_b32 s63, s31
  s_mov_b32 s28, s38
  s_and_b32 s29, s39, 0xffff
  s_mov_b32 s30, 5308416
  s_mov_b32 s31, 0x20000
  s_mov_b32 s24, s34
  s_and_b32 s25, s35, 0xffff
  s_mov_b32 s26, 5308416
  s_mov_b32 s27, 0x20000
  s_mov_b32 s32, s62
  s_and_b32 s33, s63, 0xffff
  s_mov_b32 s34, 663552
  s_mov_b32 s35, 0x20000
  s_mov_b32 s4, s4
  s_and_b32 s5, s5, 0xffff
  s_mov_b32 s6, 256
  s_mov_b32 s7, 0x20000
  s_cmp_eq_u32 s42, s41
  s_cselect_b32 s39, 0, 1
  s_cbranch_scc0 p1_kernel_nz
  v_mov_b32 v20, 0
  v_mov_b32 v21, 0
  v_mov_b32 v22, 0
  v_mov_b32 v23, 0
  v_lshlrev_b32 v24, 4, v1
  s_mul_i32 s62, s41, 6912
  s_mul_i32 s63, s3, 1728
  s_add_u32 s62, s62, s63
  s_add_u32 s62, s62, 37232640
  buffer_store_dwordx4 v[20:23], v24, s[20:23], s62 offen sc1
  v_cmp_gt_u32 vcc, 44, v1
  v_mov_b32 v25, 0x7fff0000
  s_nop 0
  v_cndmask_b32 v24, v25, v24, vcc
  buffer_store_dwordx4 v[20:23], v24, s[20:23], s62 offen offset:1024 sc1
p1_kernel_nz:
  s_add_u32 m0, s47, 0
  s_nop 0
  buffer_load_dwordx4 v32, s[8:11], s45 offen lds
  s_add_u32 m0, s47, 1024
  s_nop 0
  buffer_load_dwordx4 v33, s[8:11], s45 offen lds
  s_add_u32 m0, s47, 2048
  s_nop 0
  buffer_load_dwordx4 v34, s[8:11], s45 offen lds
  s_add_u32 m0, s47, 3072
  s_nop 0
  buffer_load_dwordx4 v35, s[8:11], s45 offen lds
  s_add_u32 m0, s48, 0
  s_nop 0
  buffer_load_dwordx4 v36, s[12:15], s46 offen lds
  s_add_u32 m0, s48, 1024
  s_nop 0
  buffer_load_dwordx4 v37, s[12:15], s46 offen lds
  s_add_u32 m0, s48, 2048
  s_nop 0
  buffer_load_dwordx4 v38, s[12:15], s46 offen lds
  s_add_u32 m0, s48, 3072
  s_nop 0
  buffer_load_dwordx4 v39, s[12:15], s46 offen lds
  s_add_u32 m0, s48, 4096
  s_nop 0
  buffer_load_dwordx4 v40, s[12:15], s46 offen lds
  s_add_u32 m0, s48, 5120
  s_nop 0
  buffer_load_dwordx4 v41, s[12:15], s46 offen lds
  s_add_u32 s45, s45, 128
  s_cmp_eq_u32 s45, s53
  s_cselect_b32 s62, 1152, 0
  s_sub_u32 s45, s45, s62
  s_add_u32 s47, s47, 16384
  s_cmp_eq_u32 s47, s54
  s_cselect_b32 s62, 49152, 0
  s_sub_u32 s47, s47, s62
  s_add_u32 s49, s49, 1
  s_cmp_ge_u32 s49, 9
  s_cselect_b32 s45, s61, s45
  s_add_u32 s46, s46, 221184
  s_cmp_eq_u32 s46, s60
  s_cselect_b32 s62, 1990656, 0
  s_sub_u32 s46, s46, s62
  s_add_u32 s48, s48, 24576
  s_cmp_eq_u32 s48, s55
  s_cselect_b32 s62, 98304, 0
  s_sub_u32 s48, s48, s62
  s_add_u32 s50, s50, 1
  s_cmp_ge_u32 s50, 9
  s_cselect_b32 s46, s61, s46
  v_lshrrev_b32 v16, 4, v1
  v_and_b32 v17, 1, v16
  v_lshrrev_b32 v18, 1, v16
  v_and_b32 v19, 15, v1
  v_lshrrev_b32 v20, 2, v19
  v_and_b32 v21, 3, v19
  v_lshrrev_b32 v22, 1, v21
  v_lshl_add_u32 v22, v17, 1, v22
  v_and_b32 v23, 1, v21
  v_lshl_add_u32 v24, v18, 3, v20
  v_mul_u32_u24 v24, 384, v24
  v_add_u32 v24, 49152, v24
  v_lshrrev_b32 v25, 1, v20
  v_lshl_add_u32 v30, v23, 2, v22
  v_lshlrev_b32 v26, 3, v30
  v_add_u32 v26, s51, v26
  v_lshrrev_b32 v27, 6, v26
  v_and_b32 v26, 63, v26
  v_add_u32 v27, v27, v25
  v_add_u32 v27, 0, v27
  v_mov_b32 v28, 0
  v_cmp_le_u32 vcc, 6, v27
  v_subrev_u32 v29, 6, v27
  s_nop 0
  v_cndmask_b32 v27, v27, v29, vcc
  v_lshrrev_b32 v29, 4, v26
  v_xor_b32 v29, v29, v28
  v_and_b32 v26, 15, v26
  v_lshl_add_u32 v26, v29, 4, v26
  v_lshl_add_u32 v26, v27, 6, v26
  v_add_u32 v2, v24, v26
  v_lshlrev_b32 v26, 3, v30
  v_add_u32 v26, s51, v26
  v_lshrrev_b32 v27, 6, v26
  v_and_b32 v26, 63, v26
  v_add_u32 v27, v27, v25
  v_add_u32 v27, 2, v27
  v_mov_b32 v28, 0
  v_cmp_le_u32 vcc, 6, v27
  v_subrev_u32 v29, 6, v27
  s_nop 0
  v_cndmask_b32 v27, v27, v29, vcc
  v_lshrrev_b32 v29, 4, v26
  v_xor_b32 v29, v29, v28
  v_and_b32 v26, 15, v26
  v_lshl_add_u32 v26, v29, 4, v26
  v_lshl_add_u32 v26, v27, 6, v26
  v_add_u32 v3, v24, v26
  v_lshlrev_b32 v26, 3, v30
  v_add_u32 v26, s51, v26
  v_lshrrev_b32 v27, 6, v26
  v_and_b32 v26, 63, v26
  v_add_u32 v27, v27, v25
  v_add_u32 v27, 4, v27
  v_mov_b32 v28, 1
  v_cmp_le_u32 vcc, 6, v27
  v_subrev_u32 v29, 6, v27
  s_nop 0
  v_cndmask_b32 v27, v27, v29, vcc
  v_lshrrev_b32 v29, 4, v26
  v_xor_b32 v29, v29, v28
  v_and_b32 v26, 15, v26
  v_lshl_add_u32 v26, v29, 4, v26
  v_lshl_add_u32 v26, v27, 6, v26
  v_add_u32 v4, v24, v26
  v_cmp_eq_u32 vcc, 3, v22
  s_nop 1
  v_cndmask_b32 v31, v22, v23, vcc
  v_lshlrev_b32 v30, 2, v23
  v_add_u32 v30, 4, v30
  v_lshlrev_b32 v26, 3, v30
  v_add_u32 v26, s51, v26
  v_lshrrev_b32 v27, 6, v26
  v_and_b32 v26, 63, v26
  v_add_u32 v27, v27, v25
  v_lshl_add_u32 v27, v31, 1, v27
  v_lshrrev_b32 v28, 1, v31
  v_cmp_le_u32 vcc, 6, v27
  v_subrev_u32 v29, 6, v27
  s_nop 0
  v_cndmask_b32 v27, v27, v29, vcc
  v_lshrrev_b32 v29, 4, v26
  v_xor_b32 v29, v29, v28
  v_and_b32 v26, 15, v26
  v_lshl_add_u32 v26, v29, 4, v26
  v_lshl_add_u32 v26, v27, 6, v26
  v_add_u32 v5, v24, v26
  v_mov_b32 v10, v2
  s_cmp_eq_u32 s3, 1
  s_cselect_b32 s62, -1, 0
  s_cselect_b32 s63, -1, 0
  v_cndmask_b32 v10, v10, v3, s[62:63]
  s_cmp_eq_u32 s3, 2
  s_cselect_b32 s62, -1, 0
  s_cselect_b32 s63, -1, 0
  v_cndmask_b32 v10, v10, v4, s[62:63]
  s_cmp_eq_u32 s3, 3
  s_cselect_b32 s62, -1, 0
  s_cselect_b32 s63, -1, 0
  v_cndmask_b32 v10, v10, v5, s[62:63]
  v_mov_b32 v130, 0
  v_mov_b32 v131, 0
  s_mov_b32 s52, 0xffff0000
  s_mov_b32 s36, 24576
  s_waitcnt vmcnt(10)
  s_barrier
  s_cmp_eq_u32 s39, 0
  s_cbranch_scc0 p1_kernel_nf
  s_cmp_eq_u32 s3, 0
  s_cbranch_scc0 p1_kernel_nf
  s_lshl_b32 s62, s41, 2
  v_mov_b32 v11, 1
  v_mov_b32 v12, 0
  buffer_store_dword v11, v12, s[4:7], s62 offen sc0 sc1
p1_kernel_nf:
  s_add_u32 m0, s48, 0
  s_nop 0
  buffer_load_dwordx4 v36, s[12:15], s46 offen lds
  s_add_u32 m0, s48, 1024
  s_nop 0
  buffer_load_dwordx4 v37, s[12:15], s46 offen lds
  s_add_u32 m0, s48, 2048
  s_nop 0
  buffer_load_dwordx4 v38, s[12:15], s46 offen lds
  s_add_u32 m0, s48, 3072
  s_nop 0
  buffer_load_dwordx4 v39, s[12:15], s46 offen lds
  s_add_u32 m0, s48, 4096
  s_nop 0
  buffer_load_dwordx4 v40, s[12:15], s46 offen lds
  s_add_u32 m0, s48, 5120
  s_nop 0
  buffer_load_dwordx4 v41, s[12:15], s46 offen lds
  s_add_u32 s46, s46, 221184
  s_cmp_eq_u32 s46, s60
  s_cselect_b32 s62, 1990656, 0
  s_sub_u32 s46, s46, s62
  s_add_u32 s48, s48, 24576
  s_cmp_eq_u32 s48, s55
  s_cselect_b32 s62, 98304, 0
  s_sub_u32 s48, s48, s62
  s_add_u32 s50, s50, 1
  s_cmp_ge_u32 s50, 9
  s_cselect_b32 s46, s61, s46
  v_lshlrev_b32 v21, 2, v1
  s_lshl_b32 s62, s3, 6
  s_add_u32 s62, s62, 156160
  v_add_u32 v21, s62, v21
  ds_read_b32 v20, v21
  v_lshrrev_b32 v64, 3, v1
  v_and_b32 v65, 7, v1
  v_and_b32 v66, 6, v64
  v_xor_b32 v65, v65, v66
  v_lshlrev_b32 v65, 4, v65
  v_add_u32 v66, 0, v64
  v_mul_u32_u24 v68, 9216, v66
  v_add_u32 v68, v68, v65
  v_mul_u32_u24 v72, 1152, v66
  v_add_u32 v72, v72, v65
  v_add_u32 v66, 8, v64
  v_mul_u32_u24 v69, 9216, v66
  v_add_u32 v69, v69, v65
  v_mul_u32_u24 v73, 1152, v66
  v_add_u32 v73, v73, v65
  v_add_u32 v66, 16, v64
  v_mul_u32_u24 v70, 9216, v66
  v_add_u32 v70, v70, v65
  v_mul_u32_u24 v74, 1152, v66
  v_add_u32 v74, v74, v65
  v_add_u32 v66, 24, v64
  v_mul_u32_u24 v71, 9216, v66
  v_add_u32 v71, v71, v65
  v_mul_u32_u24 v75, 1152, v66
  v_add_u32 v75, v75, v65
  s_waitcnt lgkmcnt(0)
  v_readlane_b32 s70, v20, 0
  v_readlane_b32 s71, v20, 1
  v_readlane_b32 s72, v20, 2
  v_readlane_b32 s73, v20, 3
  v_readlane_b32 s74, v20, 4
  v_readlane_b32 s75, v20, 5
  v_readlane_b32 s66, v20, 6
  v_readlane_b32 s67, v20, 7
  v_readlane_b32 s68, v20, 8
  v_readlane_b32 s69, v20, 9
  s_mov_b32 s44, 0
  s_mov_b32 s57, 0
p1_kernel_hl:
p1_kernel_hloop:
  ds_read_b64_tr_b16 v[16:17], v10 offset:0
  ds_read_b64_tr_b16 v[18:19], v10 offset:1536
  ds_read_b64_tr_b16 v[20:21], v10 offset:6144
  ds_read_b64_tr_b16 v[22:23], v10 offset:7680
  ds_read_b64_tr_b16 v[24:25], v10 offset:12288
  ds_read_b64_tr_b16 v[26:27], v10 offset:13824
  ds_read_b64_tr_b16 v[28:29], v10 offset:18432
  ds_read_b64_tr_b16 v[30:31], v10 offset:19968
  s_add_u32 m0, s47, 0
  s_nop 0
  buffer_load_dwordx4 v32, s[8:11], s45 offen lds
  s_add_u32 m0, s47, 1024
  s_nop 0
  buffer_load_dwordx4 v33, s[8:11], s45 offen lds
  s_add_u32 s57, s57, 1
  s_cmp_eq_u32 s57, 4
  s_cselect_b32 s59, 0xfffee000, s36
  s_cselect_b32 s57, 0, s57
  s_waitcnt lgkmcnt(0)
  v_add_u32 v10, s59, v10
  s_add_u32 m0, s47, 2048
  v_lshlrev_b32 v48, 16, v16
  v_and_b32 v49, s52, v16
  v_lshlrev_b32 v50, 16, v17
  v_and_b32 v51, s52, v17
  v_lshlrev_b32 v52, 16, v18
  v_and_b32 v53, s52, v18
  v_lshlrev_b32 v54, 16, v19
  v_and_b32 v55, s52, v19
  buffer_load_dwordx4 v34, s[8:11], s45 offen lds
  s_add_u32 m0, s47, 3072
  v_add_f32 v130, v130, v48
  v_add_f32 v131, v131, v49
  v_add_f32 v130, v130, v50
  v_add_f32 v131, v131, v51
  v_add_f32 v130, v130, v52
  v_add_f32 v131, v131, v53
  v_add_f32 v130, v130, v54
  v_add_f32 v131, v131, v55
  buffer_load_dwordx4 v35, s[8:11], s45 offen lds
  s_add_u32 s45, s45, 128
  s_cmp_eq_u32 s45, s53
  s_cselect_b32 s62, 1152, 0
  s_sub_u32 s45, s45, s62
  s_add_u32 s47, s47, 16384
  s_cmp_eq_u32 s47, s54
  s_cselect_b32 s62, 49152, 0
  s_sub_u32 s47, s47, s62
  s_add_u32 s49, s49, 1
  s_cmp_ge_u32 s49, 9
  s_cselect_b32 s45, s61, s45
  s_add_u32 m0, s48, 0
  v_lshlrev_b32 v56, 16, v20
  v_and_b32 v57, s52, v20
  v_lshlrev_b32 v58, 16, v21
  v_and_b32 v59, s52, v21
  v_lshlrev_b32 v60, 16, v22
  v_and_b32 v61, s52, v22
  v_lshlrev_b32 v62, 16, v23
  v_and_b32 v63, s52, v23
  buffer_load_dwordx4 v36, s[12:15], s46 offen lds
  s_add_u32 m0, s48, 1024
  v_add_f32 v130, v130, v56
  v_add_f32 v131, v131, v57
  v_add_f32 v130, v130, v58
  v_add_f32 v131, v131, v59
  v_add_f32 v130, v130, v60
  v_add_f32 v131, v131, v61
  v_add_f32 v130, v130, v62
  v_add_f32 v131, v131, v63
  buffer_load_dwordx4 v37, s[12:15], s46 offen lds
  s_add_u32 m0, s48, 2048
  v_lshlrev_b32 v48, 16, v24
  v_and_b32 v49, s52, v24
  v_lshlrev_b32 v50, 16, v25
  v_and_b32 v51, s52, v25
  v_lshlrev_b32 v52, 16, v26
  v_and_b32 v53, s52, v26
  v_lshlrev_b32 v54, 16, v27
  v_and_b32 v55, s52, v27
  buffer_load_dwordx4 v38, s[12:15], s46 offen lds
  s_add_u32 m0, s48, 3072
  v_add_f32 v130, v130, v48
  v_add_f32 v131, v131, v49
  v_add_f32 v130, v130, v50
  v_add_f32 v131, v131, v51
  v_add_f32 v130, v130, v52
  v_add_f32 v131, v131, v53
  v_add_f32 v130, v130, v54
  v_add_f32 v131, v131, v55
  buffer_load_dwordx4 v39, s[12:15], s46 offen lds
  s_add_u32 m0, s48, 4096
  v_lshlrev_b32 v56, 16, v28
  v_and_b32 v57, s52, v28
  v_lshlrev_b32 v58, 16, v29
  v_and_b32 v59, s52, v29
  v_lshlrev_b32 v60, 16, v30
  v_and_b32 v61, s52, v30
  v_lshlrev_b32 v62, 16, v31
  v_and_b32 v63, s52, v31
  buffer_load_dwordx4 v40, s[12:15], s46 offen lds
  s_add_u32 m0, s48, 5120
  v_add_f32 v130, v130, v56
  v_add_f32 v131, v131, v57
  v_add_f32 v130, v130, v58
  v_add_f32 v131, v131, v59
  v_add_f32 v130, v130, v60
  v_add_f32 v131, v131, v61
  v_add_f32 v130, v130, v62
  v_add_f32 v131, v131, v63
  buffer_load_dwordx4 v41, s[12:15], s46 offen lds
  s_add_u32 s46, s46, 221184
  s_cmp_eq_u32 s46, s60
  s_cselect_b32 s62, 1990656, 0
  s_sub_u32 s46, s46, s62
  s_add_u32 s48, s48, 24576
  s_cmp_eq_u32 s48, s55
  s_cselect_b32 s62, 98304, 0
  s_sub_u32 s48, s48, s62
  s_add_u32 s50, s50, 1
  s_cmp_ge_u32 s50, 9
  s_cselect_b32 s46, s61, s46
  s_waitcnt vmcnt(16)
  s_barrier
  s_add_u32 s44, s44, 1
  s_cmp_lt_u32 s44, 6
  s_cbranch_scc1 p1_kernel_hloop
  ds_read_b64_tr_b16 v[16:17], v10 offset:0
  ds_read_b64_tr_b16 v[18:19], v10 offset:1536
  ds_read_b64_tr_b16 v[20:21], v10 offset:6144
  ds_read_b64_tr_b16 v[22:23], v10 offset:7680
  ds_read_b64_tr_b16 v[24:25], v10 offset:12288
  ds_read_b64_tr_b16 v[26:27], v10 offset:13824
  ds_read_b64_tr_b16 v[28:29], v10 offset:18432
  ds_read_b64_tr_b16 v[30:31], v10 offset:19968
  s_add_u32 m0, s47, 0
  s_nop 0
  buffer_load_dwordx4 v32, s[8:11], s45 offen lds
  s_add_u32 m0, s47, 1024
  s_nop 0
  buffer_load_dwordx4 v33, s[8:11], s45 offen lds
  s_add_u32 s57, s57, 1
  s_cmp_eq_u32 s57, 4
  s_cselect_b32 s59, 0xfffee000, s36
  s_cselect_b32 s57, 0, s57
  s_waitcnt lgkmcnt(0)
  v_add_u32 v10, s59, v10
  s_add_u32 m0, s47, 2048
  v_lshlrev_b32 v48, 16, v16
  v_and_b32 v49, s52, v16
  v_lshlrev_b32 v50, 16, v17
  v_and_b32 v51, s52, v17
  v_lshlrev_b32 v52, 16, v18
  v_and_b32 v53, s52, v18
  v_lshlrev_b32 v54, 16, v19
  v_and_b32 v55, s52, v19
  buffer_load_dwordx4 v34, s[8:11], s45 offen lds
  s_add_u32 m0, s47, 3072
  v_add_f32 v130, v130, v48
  v_add_f32 v131, v131, v49
  v_add_f32 v130, v130, v50
  v_add_f32 v131, v131, v51
  v_add_f32 v130, v130, v52
  v_add_f32 v131, v131, v53
  v_add_f32 v130, v130, v54
  v_add_f32 v131, v131, v55
  buffer_load_dwordx4 v35, s[8:11], s45 offen lds
  v_lshlrev_b32 v56, 16, v20
  v_and_b32 v57, s52, v20
  v_lshlrev_b32 v58, 16, v21
  v_and_b32 v59, s52, v21
  v_lshlrev_b32 v60, 16, v22
  v_and_b32 v61, s52, v22
  v_lshlrev_b32 v62, 16, v23
  v_and_b32 v63, s52, v23
  v_add_f32 v130, v130, v56
  v_add_f32 v131, v131, v57
  v_add_f32 v130, v130, v58
  v_add_f32 v131, v131, v59
  v_add_f32 v130, v130, v60
  v_add_f32 v131, v131, v61
  v_add_f32 v130, v130, v62
  v_add_f32 v131, v131, v63
  v_lshlrev_b32 v48, 16, v24
  v_and_b32 v49, s52, v24
  v_lshlrev_b32 v50, 16, v25
  v_and_b32 v51, s52, v25
  v_lshlrev_b32 v52, 16, v26
  v_and_b32 v53, s52, v26
  v_lshlrev_b32 v54, 16, v27
  v_and_b32 v55, s52, v27
  v_add_f32 v130, v130, v48
  v_add_f32 v131, v131, v49
  v_add_f32 v130, v130, v50
  v_add_f32 v131, v131, v51
  v_add_f32 v130, v130, v52
  v_add_f32 v131, v131, v53
  v_add_f32 v130, v130, v54
  v_add_f32 v131, v131, v55
  v_lshlrev_b32 v56, 16, v28
  v_and_b32 v57, s52, v28
  v_lshlrev_b32 v58, 16, v29
  v_and_b32 v59, s52, v29
  v_lshlrev_b32 v60, 16, v30
  v_and_b32 v61, s52, v30
  v_lshlrev_b32 v62, 16, v31
  v_and_b32 v63, s52, v31
  v_add_f32 v130, v130, v56
  v_add_f32 v131, v131, v57
  v_add_f32 v130, v130, v58
  v_add_f32 v131, v131, v59
  v_add_f32 v130, v130, v60
  v_add_f32 v131, v131, v61
  v_add_f32 v130, v130, v62
  v_add_f32 v131, v131, v63
  s_mul_i32 s63, s3, 6144
  s_add_u32 s63, s63, 73728
  s_cmp_eq_u32 s70, 0
  s_cbranch_scc0 p1_kernel_sj0_n0
  s_add_u32 m0, s63, 0
  s_nop 0
  buffer_load_dwordx4 v68, s[24:27], s73 offen lds
  s_add_u32 m0, s63, 1024
  s_nop 0
  buffer_load_dwordx4 v69, s[24:27], s73 offen lds
  s_add_u32 m0, s63, 2048
  s_nop 0
  buffer_load_dwordx4 v70, s[24:27], s73 offen lds
  s_add_u32 m0, s63, 3072
  s_nop 0
  buffer_load_dwordx4 v71, s[24:27], s73 offen lds
  s_branch p1_kernel_sj0_d
p1_kernel_sj0_n0:
  s_add_u32 m0, s63, 0
  s_nop 0
  buffer_load_dwordx4 v72, s[28:31], s73 offen lds
  s_add_u32 m0, s63, 1024
  s_nop 0
  buffer_load_dwordx4 v73, s[28:31], s73 offen lds
  s_add_u32 m0, s63, 2048
  s_nop 0
  buffer_load_dwordx4 v74, s[28:31], s73 offen lds
  s_add_u32 m0, s63, 3072
  s_nop 0
  buffer_load_dwordx4 v75, s[28:31], s73 offen lds
p1_kernel_sj0_d:
  s_waitcnt vmcnt(14)
  s_barrier
  ds_read_b64_tr_b16 v[16:17], v10 offset:0
  ds_read_b64_tr_b16 v[18:19], v10 offset:1536
  ds_read_b64_tr_b16 v[20:21], v10 offset:6144
  ds_read_b64_tr_b16 v[22:23], v10 offset:7680
  ds_read_b64_tr_b16 v[24:25], v10 offset:12288
  ds_read_b64_tr_b16 v[26:27], v10 offset:13824
  ds_read_b64_tr_b16 v[28:29], v10 offset:18432
  ds_read_b64_tr_b16 v[30:31], v10 offset:19968
  s_add_u32 s57, s57, 1
  s_cmp_eq_u32 s57, 4
  s_cselect_b32 s59, 0xfffee000, s36
  s_cselect_b32 s57, 0, s57
  s_waitcnt lgkmcnt(0)
  v_add_u32 v10, s59, v10
  v_lshlrev_b32 v48, 16, v16
  v_and_b32 v49, s52, v16
  v_lshlrev_b32 v50, 16, v17
  v_and_b32 v51, s52, v17
  v_lshlrev_b32 v52, 16, v18
  v_and_b32 v53, s52, v18
  v_lshlrev_b32 v54, 16, v19
  v_and_b32 v55, s52, v19
  v_add_f32 v130, v130, v48
  v_add_f32 v131, v131, v49
  v_add_f32 v130, v130, v50
  v_add_f32 v131, v131, v51
  v_add_f32 v130, v130, v52
  v_add_f32 v131, v131, v53
  v_add_f32 v130, v130, v54
  v_add_f32 v131, v131, v55
  v_lshlrev_b32 v56, 16, v20
  v_and_b32 v57, s52, v20
  v_lshlrev_b32 v58, 16, v21
  v_and_b32 v59, s52, v21
  v_lshlrev_b32 v60, 16, v22
  v_and_b32 v61, s52, v22
  v_lshlrev_b32 v62, 16, v23
  v_and_b32 v63, s52, v23
  v_add_f32 v130, v130, v56
  v_add_f32 v131, v131, v57
  v_add_f32 v130, v130, v58
  v_add_f32 v131, v131, v59
  v_add_f32 v130, v130, v60
  v_add_f32 v131, v131, v61
  v_add_f32 v130, v130, v62
  v_add_f32 v131, v131, v63
  v_lshlrev_b32 v48, 16, v24
  v_and_b32 v49, s52, v24
  v_lshlrev_b32 v50, 16, v25
  v_and_b32 v51, s52, v25
  v_lshlrev_b32 v52, 16, v26
  v_and_b32 v53, s52, v26
  v_lshlrev_b32 v54, 16, v27
  v_and_b32 v55, s52, v27
  v_add_f32 v130, v130, v48
  v_add_f32 v131, v131, v49
  v_add_f32 v130, v130, v50
  v_add_f32 v131, v131, v51
  v_add_f32 v130, v130, v52
  v_add_f32 v131, v131, v53
  v_add_f32 v130, v130, v54
  v_add_f32 v131, v131, v55
  v_lshlrev_b32 v56, 16, v28
  v_and_b32 v57, s52, v28
  v_lshlrev_b32 v58, 16, v29
  v_and_b32 v59, s52, v29
  v_lshlrev_b32 v60, 16, v30
  v_and_b32 v61, s52, v30
  v_lshlrev_b32 v62, 16, v31
  v_and_b32 v63, s52, v31
  v_add_f32 v130, v130, v56
  v_add_f32 v131, v131, v57
  v_add_f32 v130, v130, v58
  v_add_f32 v131, v131, v59
  v_add_f32 v130, v130, v60
  v_add_f32 v131, v131, v61
  v_add_f32 v130, v130, v62
  v_add_f32 v131, v131, v63
  s_mul_i32 s63, s3, 6144
  s_add_u32 s63, s63, 98304
  s_cmp_eq_u32 s71, 0
  s_cbranch_scc0 p1_kernel_sj1_n0
  s_add_u32 m0, s63, 0
  s_nop 0
  buffer_load_dwordx4 v68, s[24:27], s74 offen lds
  s_add_u32 m0, s63, 1024
  s_nop 0
  buffer_load_dwordx4 v69, s[24:27], s74 offen lds
  s_add_u32 m0, s63, 2048
  s_nop 0
  buffer_load_dwordx4 v70, s[24:27], s74 offen lds
  s_add_u32 m0, s63, 3072
  s_nop 0
  buffer_load_dwordx4 v71, s[24:27], s74 offen lds
  s_branch p1_kernel_sj1_d
p1_kernel_sj1_n0:
  s_add_u32 m0, s63, 0
  s_nop 0
  buffer_load_dwordx4 v72, s[28:31], s74 offen lds
  s_add_u32 m0, s63, 1024
  s_nop 0
  buffer_load_dwordx4 v73, s[28:31], s74 offen lds
  s_add_u32 m0, s63, 2048
  s_nop 0
  buffer_load_dwordx4 v74, s[28:31], s74 offen lds
  s_add_u32 m0, s63, 3072
  s_nop 0
  buffer_load_dwordx4 v75, s[28:31], s74 offen lds
p1_kernel_sj1_d:
  s_waitcnt vmcnt(8)
  s_barrier
  ds_read_b64_tr_b16 v[16:17], v10 offset:0
  ds_read_b64_tr_b16 v[18:19], v10 offset:1536
  ds_read_b64_tr_b16 v[20:21], v10 offset:6144
  ds_read_b64_tr_b16 v[22:23], v10 offset:7680
  ds_read_b64_tr_b16 v[24:25], v10 offset:12288
  ds_read_b64_tr_b16 v[26:27], v10 offset:13824
  ds_read_b64_tr_b16 v[28:29], v10 offset:18432
  ds_read_b64_tr_b16 v[30:31], v10 offset:19968
  s_add_u32 s57, s57, 1
  s_cmp_eq_u32 s57, 4
  s_cselect_b32 s59, 0xfffee000, s36
  s_cselect_b32 s57, 0, s57
  s_waitcnt lgkmcnt(0)
  v_add_u32 v10, s59, v10
  v_lshlrev_b32 v48, 16, v16
  v_and_b32 v49, s52, v16
  v_lshlrev_b32 v50, 16, v17
  v_and_b32 v51, s52, v17
  v_lshlrev_b32 v52, 16, v18
  v_and_b32 v53, s52, v18
  v_lshlrev_b32 v54, 16, v19
  v_and_b32 v55, s52, v19
  v_add_f32 v130, v130, v48
  v_add_f32 v131, v131, v49
  v_add_f32 v130, v130, v50
  v_add_f32 v131, v131, v51
  v_add_f32 v130, v130, v52
  v_add_f32 v131, v131, v53
  v_add_f32 v130, v130, v54
  v_add_f32 v131, v131, v55
  v_lshlrev_b32 v56, 16, v20
  v_and_b32 v57, s52, v20
  v_lshlrev_b32 v58, 16, v21
  v_and_b32 v59, s52, v21
  v_lshlrev_b32 v60, 16, v22
  v_and_b32 v61, s52, v22
  v_lshlrev_b32 v62, 16, v23
  v_and_b32 v63, s52, v23
  v_add_f32 v130, v130, v56
  v_add_f32 v131, v131, v57
  v_add_f32 v130, v130, v58
  v_add_f32 v131, v131, v59
  v_add_f32 v130, v130, v60
  v_add_f32 v131, v131, v61
  v_add_f32 v130, v130, v62
  v_add_f32 v131, v131, v63
  v_lshlrev_b32 v48, 16, v24
  v_and_b32 v49, s52, v24
  v_lshlrev_b32 v50, 16, v25
  v_and_b32 v51, s52, v25
  v_lshlrev_b32 v52, 16, v26
  v_and_b32 v53, s52, v26
  v_lshlrev_b32 v54, 16, v27
  v_and_b32 v55, s52, v27
  v_add_f32 v130, v130, v48
  v_add_f32 v131, v131, v49
  v_add_f32 v130, v130, v50
  v_add_f32 v131, v131, v51
  v_add_f32 v130, v130, v52
  v_add_f32 v131, v131, v53
  v_add_f32 v130, v130, v54
  v_add_f32 v131, v131, v55
  v_lshlrev_b32 v56, 16, v28
  v_and_b32 v57, s52, v28
  v_lshlrev_b32 v58, 16, v29
  v_and_b32 v59, s52, v29
  v_lshlrev_b32 v60, 16, v30
  v_and_b32 v61, s52, v30
  v_lshlrev_b32 v62, 16, v31
  v_and_b32 v63, s52, v31
  v_add_f32 v130, v130, v56
  v_add_f32 v131, v131, v57
  v_add_f32 v130, v130, v58
  v_add_f32 v131, v131, v59
  v_add_f32 v130, v130, v60
  v_add_f32 v131, v131, v61
  v_add_f32 v130, v130, v62
  v_add_f32 v131, v131, v63
  s_mul_i32 s63, s3, 6144
  s_add_u32 s63, s63, 122880
  s_cmp_eq_u32 s72, 0
  s_cbranch_scc0 p1_kernel_sj2_n0
  s_add_u32 m0, s63, 0
  s_nop 0
  buffer_load_dwordx4 v68, s[24:27], s75 offen lds
  s_add_u32 m0, s63, 1024
  s_nop 0
  buffer_load_dwordx4 v69, s[24:27], s75 offen lds
  s_add_u32 m0, s63, 2048
  s_nop 0
  buffer_load_dwordx4 v70, s[24:27], s75 offen lds
  s_add_u32 m0, s63, 3072
  s_nop 0
  buffer_load_dwordx4 v71, s[24:27], s75 offen lds
  s_branch p1_kernel_sj2_d
p1_kernel_sj2_n0:
  s_cmp_eq_u32 s72, 2
  s_cbranch_scc0 p1_kernel_sj2_n2
  v_add_u32 v76, 0, v64
  v_and_b32 v77, 15, v76
  v_lshrrev_b32 v77, 2, v77
  v_and_b32 v78, 3, v76
  v_lshrrev_b32 v79, 4, v76
  v_lshl_add_u32 v78, v79, 2, v78
  s_lshl_b32 s62, s69, 2
  v_add_u32 v77, s62, v77
  v_mul_u32_u24 v79, 57, v77
  v_lshrrev_b32 v79, 9, v79
  v_mul_u32_u24 v80, 9, v79
  v_sub_u32 v80, v77, v80
  v_lshl_add_u32 v80, v80, 3, v78
  v_mul_u32_u24 v81, 57, v80
  v_lshrrev_b32 v81, 9, v81
  v_mul_u32_u24 v82, 9, v81
  v_sub_u32 v82, v80, v82
  v_lshrrev_b32 v83, 1, v79
  v_and_b32 v84, 1, v79
  v_lshl_add_u32 v83, v83, 3, v81
  v_mul_u32_u24 v83, 18, v83
  v_mul_u32_u24 v84, 9, v84
  v_add3_u32 v76, v83, v84, v82
  v_mul_u32_u24 v76, 1152, v76
  v_add_u32 v76, v76, v65
  s_add_u32 m0, s63, 0
  s_nop 0
  buffer_load_dwordx4 v76, s[32:35], s75 offen lds
  v_add_u32 v76, 8, v64
  v_and_b32 v77, 15, v76
  v_lshrrev_b32 v77, 2, v77
  v_and_b32 v78, 3, v76
  v_lshrrev_b32 v79, 4, v76
  v_lshl_add_u32 v78, v79, 2, v78
  s_lshl_b32 s62, s69, 2
  v_add_u32 v77, s62, v77
  v_mul_u32_u24 v79, 57, v77
  v_lshrrev_b32 v79, 9, v79
  v_mul_u32_u24 v80, 9, v79
  v_sub_u32 v80, v77, v80
  v_lshl_add_u32 v80, v80, 3, v78
  v_mul_u32_u24 v81, 57, v80
  v_lshrrev_b32 v81, 9, v81
  v_mul_u32_u24 v82, 9, v81
  v_sub_u32 v82, v80, v82
  v_lshrrev_b32 v83, 1, v79
  v_and_b32 v84, 1, v79
  v_lshl_add_u32 v83, v83, 3, v81
  v_mul_u32_u24 v83, 18, v83
  v_mul_u32_u24 v84, 9, v84
  v_add3_u32 v76, v83, v84, v82
  v_mul_u32_u24 v76, 1152, v76
  v_add_u32 v76, v76, v65
  s_add_u32 m0, s63, 1024
  s_nop 0
  buffer_load_dwordx4 v76, s[32:35], s75 offen lds
  v_add_u32 v76, 16, v64
  v_and_b32 v77, 15, v76
  v_lshrrev_b32 v77, 2, v77
  v_and_b32 v78, 3, v76
  v_lshrrev_b32 v79, 4, v76
  v_lshl_add_u32 v78, v79, 2, v78
  s_lshl_b32 s62, s69, 2
  v_add_u32 v77, s62, v77
  v_mul_u32_u24 v79, 57, v77
  v_lshrrev_b32 v79, 9, v79
  v_mul_u32_u24 v80, 9, v79
  v_sub_u32 v80, v77, v80
  v_lshl_add_u32 v80, v80, 3, v78
  v_mul_u32_u24 v81, 57, v80
  v_lshrrev_b32 v81, 9, v81
  v_mul_u32_u24 v82, 9, v81
  v_sub_u32 v82, v80, v82
  v_lshrrev_b32 v83, 1, v79
  v_and_b32 v84, 1, v79
  v_lshl_add_u32 v83, v83, 3, v81
  v_mul_u32_u24 v83, 18, v83
  v_mul_u32_u24 v84, 9, v84
  v_add3_u32 v76, v83, v84, v82
  v_mul_u32_u24 v76, 1152, v76
  v_add_u32 v76, v76, v65
  s_add_u32 m0, s63, 2048
  s_nop 0
  buffer_load_dwordx4 v76, s[32:35], s75 offen lds
  v_add_u32 v76, 24, v64
  v_and_b32 v77, 15, v76
  v_lshrrev_b32 v77, 2, v77
  v_and_b32 v78, 3, v76
  v_lshrrev_b32 v79, 4, v76
  v_lshl_add_u32 v78, v79, 2, v78
  s_lshl_b32 s62, s69, 2
  v_add_u32 v77, s62, v77
  v_mul_u32_u24 v79, 57, v77
  v_lshrrev_b32 v79, 9, v79
  v_mul_u32_u24 v80, 9, v79
  v_sub_u32 v80, v77, v80
  v_lshl_add_u32 v80, v80, 3, v78
  v_mul_u32_u24 v81, 57, v80
  v_lshrrev_b32 v81, 9, v81
  v_mul_u32_u24 v82, 9, v81
  v_sub_u32 v82, v80, v82
  v_lshrrev_b32 v83, 1, v79
  v_and_b32 v84, 1, v79
  v_lshl_add_u32 v83, v83, 3, v81
  v_mul_u32_u24 v83, 18, v83
  v_mul_u32_u24 v84, 9, v84
  v_add3_u32 v76, v83, v84, v82
  v_mul_u32_u24 v76, 1152, v76
  v_add_u32 v76, v76, v65
  s_add_u32 m0, s63, 3072
  s_nop 0
  buffer_load_dwordx4 v76, s[32:35], s75 offen lds
  s_branch p1_kernel_sj2_d
p1_kernel_sj2_n2:
  s_cmp_eq_u32 s72, 3
  s_cselect_b32 s75, s61, s75
  s_add_u32 m0, s63, 0
  s_nop 0
  buffer_load_dwordx4 v72, s[28:31], s75 offen lds
  s_add_u32 m0, s63, 1024
  s_nop 0
  buffer_load_dwordx4 v73, s[28:31], s75 offen lds
  s_add_u32 m0, s63, 2048
  s_nop 0
  buffer_load_dwordx4 v74, s[28:31], s75 offen lds
  s_add_u32 m0, s63, 3072
  s_nop 0
  buffer_load_dwordx4 v75, s[28:31], s75 offen lds
p1_kernel_sj2_d:
  s_waitcnt vmcnt(63)
  s_barrier
  v_add_f32 v130, v130, v131
  v_mov_b32 v160, v130
  v_and_b32 v16, 31, v1
  v_lshlrev_b32 v16, 2, v16
  v_permlane32_swap_b32 v130, v160
  s_lshl_b32 s62, s3, 7
  s_add_u32 s62, s62, 149504
  v_add_u32 v16, s62, v16
  v_add_f32 v130, v130, v160
  ds_write_b32 v16, v130
  s_waitcnt lgkmcnt(0)
  v_lshlrev_b32 v17, 4, v1
  v_add_u32 v17, 150016, v17
  ds_read_b128 v[136:139], v17 offset:0
  ds_read_b128 v[140:143], v17 offset:1024
  ds_read_b128 v[144:147], v17 offset:2048
  ds_read_b128 v[148:151], v17 offset:3072
  ds_read_b128 v[152:155], v17 offset:4096
  ds_read_b128 v[156:159], v17 offset:5120
  s_waitcnt lgkmcnt(0)
  s_barrier
  s_mul_i32 s62, s3, 3072
  s_add_u32 s62, s62, 49152
  v_lshlrev_b32 v43, 4, v1
  v_add_u32 v43, s62, v43
  s_barrier
  ds_read_b128 v[16:19], v43 offset:0
  ds_read_b128 v[20:23], v43 offset:1024
  ds_read_b128 v[24:27], v43 offset:2048
  s_waitcnt lgkmcnt(0)
  v_mov_b32 v46, v26
  v_mov_b32 v47, v27
  v_mov_b32 v26, 0
  v_mov_b32 v27, 0
  s_nop 1
  v_mfma_f32_32x32x16_bf16 v[64:79], v[136:139], v[16:19], 0
  v_mfma_f32_32x32x16_bf16 v[64:79], v[140:143], v[20:23], v[64:79]
  v_mfma_f32_32x32x16_bf16 v[64:79], v[144:147], v[24:27], v[64:79]
  v_mfma_f32_32x32x16_bf16 v[80:95], v[148:151], v[16:19], 0
  v_mfma_f32_32x32x16_bf16 v[80:95], v[152:155], v[20:23], v[80:95]
  v_mfma_f32_32x32x16_bf16 v[80:95], v[156:159], v[24:27], v[80:95]
  v_and_b32 v16, 31, v1
  v_lshrrev_b32 v17, 5, v1
  v_mul_u32_u24 v17, 2304, v17
  v_lshl_add_u32 v40, v16, 4, v17
  v_lshl_add_u32 v41, v16, 2, v17
  s_lshl_b32 s62, s43, 5
  s_lshl_b32 s63, s41, 1
  s_add_u32 s62, s62, s63
  s_mul_i32 s62, s62, 2304
  s_add_u32 s58, s62, 32514048
  s_nop 7
  s_nop 3
  v_max3_f32 v44, v64, v65, v66
  v_min3_f32 v45, v64, v65, v66
  v_max3_f32 v44, v44, v67, v68
  v_min3_f32 v45, v45, v67, v68
  v_max3_f32 v44, v44, v69, v70
  v_min3_f32 v45, v45, v69, v70
  v_max3_f32 v44, v44, v71, v72
  v_min3_f32 v45, v45, v71, v72
  v_max3_f32 v44, v44, v73, v74
  v_min3_f32 v45, v45, v73, v74
  v_max3_f32 v44, v44, v75, v76
  v_min3_f32 v45, v45, v75, v76
  v_max3_f32 v44, v44, v77, v78
  v_min3_f32 v45, v45, v77, v78
  v_max3_f32 v44, v44, v79, v80
  v_min3_f32 v45, v45, v79, v80
  v_max_f32 v44, v44, v81
  v_min_f32 v45, v45, v81
  v_pk_mul_f32 v[44:45], v[44:45], v[46:47] op_sel:[0,1] op_sel_hi:[1,0]
  v_pk_fma_f32 v[192:193], v[64:65], v[46:47], v[44:45] op_sel:[0,0,0] op_sel_hi:[0,1,1]
  v_pk_fma_f32 v[194:195], v[64:65], v[46:47], v[44:45] op_sel:[1,0,0] op_sel_hi:[1,1,1]
  v_pk_fma_f32 v[196:197], v[66:67], v[46:47], v[44:45] op_sel:[0,0,0] op_sel_hi:[0,1,1]
  v_exp_f32 v192, v192
  v_exp_f32 v193, v193
  v_pk_fma_f32 v[198:199], v[66:67], v[46:47], v[44:45] op_sel:[1,0,0] op_sel_hi:[1,1,1]
  v_exp_f32 v194, v194
  v_exp_f32 v195, v195
  v_pk_fma_f32 v[200:201], v[68:69], v[46:47], v[44:45] op_sel:[0,0,0] op_sel_hi:[0,1,1]
  v_exp_f32 v196, v196
  v_exp_f32 v197, v197
  v_pk_fma_f32 v[202:203], v[68:69], v[46:47], v[44:45] op_sel:[1,0,0] op_sel_hi:[1,1,1]
  v_exp_f32 v198, v198
  v_exp_f32 v199, v199
  v_pk_fma_f32 v[204:205], v[70:71], v[46:47], v[44:45] op_sel:[0,0,0] op_sel_hi:[0,1,1]
  v_exp_f32 v200, v200
  v_exp_f32 v201, v201
  v_pk_fma_f32 v[206:207], v[70:71], v[46:47], v[44:45] op_sel:[1,0,0] op_sel_hi:[1,1,1]
  v_exp_f32 v202, v202
  v_exp_f32 v203, v203
  v_pk_fma_f32 v[208:209], v[72:73], v[46:47], v[44:45] op_sel:[0,0,0] op_sel_hi:[0,1,1]
  v_exp_f32 v204, v204
  v_exp_f32 v205, v205
  v_pk_fma_f32 v[210:211], v[72:73], v[46:47], v[44:45] op_sel:[1,0,0] op_sel_hi:[1,1,1]
  v_exp_f32 v206, v206
  v_exp_f32 v207, v207
  v_pk_fma_f32 v[212:213], v[74:75], v[46:47], v[44:45] op_sel:[0,0,0] op_sel_hi:[0,1,1]
  v_exp_f32 v208, v208
  v_exp_f32 v209, v209
  v_pk_fma_f32 v[214:215], v[74:75], v[46:47], v[44:45] op_sel:[1,0,0] op_sel_hi:[1,1,1]
  v_exp_f32 v210, v210
  v_exp_f32 v211, v211
  v_pk_fma_f32 v[216:217], v[76:77], v[46:47], v[44:45] op_sel:[0,0,0] op_sel_hi:[0,1,1]
  v_exp_f32 v212, v212
  v_exp_f32 v213, v213
  v_pk_fma_f32 v[218:219], v[76:77], v[46:47], v[44:45] op_sel:[1,0,0] op_sel_hi:[1,1,1]
  v_exp_f32 v214, v214
  v_exp_f32 v215, v215
  v_pk_fma_f32 v[220:221], v[78:79], v[46:47], v[44:45] op_sel:[0,0,0] op_sel_hi:[0,1,1]
  v_exp_f32 v216, v216
  v_exp_f32 v217, v217
  v_pk_fma_f32 v[222:223], v[78:79], v[46:47], v[44:45] op_sel:[1,0,0] op_sel_hi:[1,1,1]
  v_exp_f32 v218, v218
  v_exp_f32 v219, v219
  v_pk_fma_f32 v[224:225], v[80:81], v[46:47], v[44:45] op_sel:[0,0,0] op_sel_hi:[0,1,1]
  v_exp_f32 v220, v220
  v_exp_f32 v221, v221
  v_pk_fma_f32 v[226:227], v[80:81], v[46:47], v[44:45] op_sel:[1,0,0] op_sel_hi:[1,1,1]
  v_exp_f32 v222, v222
  v_exp_f32 v223, v223
  v_exp_f32 v224, v224
  v_exp_f32 v225, v225
  v_exp_f32 v226, v226
  v_exp_f32 v227, v227
  v_pk_add_f32 v[228:229], v[192:193], v[194:195]
  v_pk_add_f32 v[44:45], v[196:197], v[198:199]
  v_pk_add_f32 v[228:229], v[228:229], v[200:201]
  v_pk_add_f32 v[44:45], v[44:45], v[202:203]
  v_pk_add_f32 v[228:229], v[228:229], v[204:205]
  v_pk_add_f32 v[44:45], v[44:45], v[206:207]
  v_pk_add_f32 v[228:229], v[228:229], v[208:209]
  v_pk_add_f32 v[44:45], v[44:45], v[210:211]
  v_pk_add_f32 v[228:229], v[228:229], v[212:213]
  v_pk_add_f32 v[44:45], v[44:45], v[214:215]
  v_pk_add_f32 v[228:229], v[228:229], v[216:217]
  v_pk_add_f32 v[44:45], v[44:45], v[218:219]
  v_pk_add_f32 v[228:229], v[228:229], v[220:221]
  v_pk_add_f32 v[44:45], v[44:45], v[222:223]
  v_pk_add_f32 v[228:229], v[228:229], v[224:225]
  v_pk_add_f32 v[44:45], v[44:45], v[226:227]
  v_pk_add_f32 v[228:229], v[228:229], v[44:45]
  v_rcp_f32 v228, v228
  v_rcp_f32 v229, v229
  s_nop 0
  v_pk_mul_f32 v[192:193], v[192:193], v[228:229]
  v_pk_mul_f32 v[194:195], v[194:195], v[228:229]
  v_pk_mul_f32 v[196:197], v[196:197], v[228:229]
  v_pk_mul_f32 v[198:199], v[198:199], v[228:229]
  v_cvt_pk_bf16_f32 v168, v192, v194
  v_cvt_pk_bf16_f32 v180, v193, v195
  v_pk_mul_f32 v[200:201], v[200:201], v[228:229]
  v_pk_mul_f32 v[202:203], v[202:203], v[228:229]
  v_cvt_pk_bf16_f32 v169, v196, v198
  v_cvt_pk_bf16_f32 v181, v197, v199
  v_pk_mul_f32 v[204:205], v[204:205], v[228:229]
  v_pk_mul_f32 v[206:207], v[206:207], v[228:229]
  v_cvt_pk_bf16_f32 v170, v200, v202
  v_cvt_pk_bf16_f32 v182, v201, v203
  v_pk_mul_f32 v[208:209], v[208:209], v[228:229]
  v_pk_mul_f32 v[210:211], v[210:211], v[228:229]
  v_cvt_pk_bf16_f32 v171, v204, v206
  v_cvt_pk_bf16_f32 v183, v205, v207
  v_pk_mul_f32 v[212:213], v[212:213], v[228:229]
  v_pk_mul_f32 v[214:215], v[214:215], v[228:229]
  v_cvt_pk_bf16_f32 v172, v208, v210
  v_cvt_pk_bf16_f32 v184, v209, v211
  v_pk_mul_f32 v[216:217], v[216:217], v[228:229]
  v_pk_mul_f32 v[218:219], v[218:219], v[228:229]
  v_cvt_pk_bf16_f32 v173, v212, v214
  v_cvt_pk_bf16_f32 v185, v213, v215
  v_pk_mul_f32 v[220:221], v[220:221], v[228:229]
  v_pk_mul_f32 v[222:223], v[222:223], v[228:229]
  v_cvt_pk_bf16_f32 v174, v216, v218
  v_cvt_pk_bf16_f32 v186, v217, v219
  v_pk_mul_f32 v[224:225], v[224:225], v[228:229]
  v_pk_mul_f32 v[226:227], v[226:227], v[228:229]
  v_cvt_pk_bf16_f32 v175, v220, v222
  v_cvt_pk_bf16_f32 v187, v221, v223
  v_cvt_pk_bf16_f32 v176, v224, v226
  v_cvt_pk_bf16_f32 v188, v225, v227
  buffer_store_dwordx4 v[168:171], v40, s[20:23], s58 offen sc1
  buffer_store_dwordx4 v[172:175], v40, s[20:23], s58 offen offset:1024 sc1
  buffer_store_dword v176, v41, s[20:23], s58 offen offset:2048 sc1
  buffer_store_dwordx4 v[180:183], v40, s[20:23], s58 offen offset:512 sc1
  buffer_store_dwordx4 v[184:187], v40, s[20:23], s58 offen offset:1536 sc1
  buffer_store_dword v188, v41, s[20:23], s58 offen offset:2176 sc1
  s_waitcnt vmcnt(10)
  v_lshrrev_b32 v200, 4, v1
  v_and_b32 v201, 15, v1
  v_lshrrev_b32 v202, 2, v201
  v_lshl_add_u32 v202, v200, 2, v202
  v_and_b32 v203, 3, v201
  v_lshrrev_b32 v204, 1, v203
  v_and_b32 v205, 1, v203
  v_and_b32 v206, 6, v202
  s_mul_i32 s62, s3, 6144
  s_add_u32 s62, s62, 73728
  v_add_u32 v207, 0, v204
  v_xor_b32 v207, v207, v206
  v_lshlrev_b32 v207, 4, v207
  v_lshl_add_u32 v208, v202, 7, v207
  v_lshl_add_u32 v208, v205, 3, v208
  v_add_u32 v208, s62, v208
  v_add_u32 v207, 2, v204
  v_xor_b32 v207, v207, v206
  v_lshlrev_b32 v207, 4, v207
  v_lshl_add_u32 v209, v202, 7, v207
  v_lshl_add_u32 v209, v205, 3, v209
  v_add_u32 v209, s62, v209
  v_add_u32 v207, 4, v204
  v_xor_b32 v207, v207, v206
  v_lshlrev_b32 v207, 4, v207
  v_lshl_add_u32 v210, v202, 7, v207
  v_lshl_add_u32 v210, v205, 3, v210
  v_add_u32 v210, s62, v210
  v_add_u32 v207, 6, v204
  v_xor_b32 v207, v207, v206
  v_lshlrev_b32 v207, 4, v207
  v_lshl_add_u32 v211, v202, 7, v207
  v_lshl_add_u32 v211, v205, 3, v211
  v_add_u32 v211, s62, v211
  v_lshlrev_b32 v212, 4, v1
  s_barrier
  s_barrier
  s_waitcnt vmcnt(0)
  ds_read_b64_tr_b16 v[216:217], v208 offset:0
  ds_read_b64_tr_b16 v[218:219], v208 offset:2048
  ds_read_b64_tr_b16 v[220:221], v209 offset:0
  ds_read_b64_tr_b16 v[222:223], v209 offset:2048
  ds_read_b64_tr_b16 v[224:225], v210 offset:0
  ds_read_b64_tr_b16 v[226:227], v210 offset:2048
  ds_read_b64_tr_b16 v[228:229], v211 offset:0
  ds_read_b64_tr_b16 v[230:231], v211 offset:2048
  s_waitcnt lgkmcnt(6)
  buffer_store_dwordx4 v[216:219], v212, s[20:23], s66 offen sc1
  s_add_u32 s66, s66, 18432
  s_waitcnt lgkmcnt(4)
  buffer_store_dwordx4 v[220:223], v212, s[20:23], s66 offen sc1
  s_add_u32 s66, s66, 18432
  s_waitcnt lgkmcnt(2)
  buffer_store_dwordx4 v[224:227], v212, s[20:23], s66 offen sc1
  s_add_u32 s66, s66, 18432
  s_waitcnt lgkmcnt(0)
  buffer_store_dwordx4 v[228:231], v212, s[20:23], s66 offen sc1
  ds_read_b64_tr_b16 v[232:233], v208 offset:24576
  ds_read_b64_tr_b16 v[234:235], v208 offset:26624
  ds_read_b64_tr_b16 v[236:237], v209 offset:24576
  ds_read_b64_tr_b16 v[238:239], v209 offset:26624
  ds_read_b64_tr_b16 v[240:241], v210 offset:24576
  ds_read_b64_tr_b16 v[242:243], v210 offset:26624
  ds_read_b64_tr_b16 v[244:245], v211 offset:24576
  ds_read_b64_tr_b16 v[246:247], v211 offset:26624
  s_waitcnt lgkmcnt(6)
  buffer_store_dwordx4 v[232:235], v212, s[20:23], s67 offen sc1
  s_add_u32 s67, s67, 18432
  s_waitcnt lgkmcnt(4)
  buffer_store_dwordx4 v[236:239], v212, s[20:23], s67 offen sc1
  s_add_u32 s67, s67, 18432
  s_waitcnt lgkmcnt(2)
  buffer_store_dwordx4 v[240:243], v212, s[20:23], s67 offen sc1
  s_add_u32 s67, s67, 18432
  s_waitcnt lgkmcnt(0)
  buffer_store_dwordx4 v[244:247], v212, s[20:23], s67 offen sc1
  s_cmp_eq_u32 s72, 3
  s_cbranch_scc1 p1_kernel_sjend
  ds_read_b64_tr_b16 v[216:217], v208 offset:49152
  ds_read_b64_tr_b16 v[218:219], v208 offset:51200
  ds_read_b64_tr_b16 v[220:221], v209 offset:49152
  ds_read_b64_tr_b16 v[222:223], v209 offset:51200
  ds_read_b64_tr_b16 v[224:225], v210 offset:49152
  ds_read_b64_tr_b16 v[226:227], v210 offset:51200
  ds_read_b64_tr_b16 v[228:229], v211 offset:49152
  ds_read_b64_tr_b16 v[230:231], v211 offset:51200
  s_waitcnt lgkmcnt(6)
  buffer_store_dwordx4 v[216:219], v212, s[20:23], s68 offen sc1
  s_add_u32 s68, s68, 18432
  s_waitcnt lgkmcnt(4)
  buffer_store_dwordx4 v[220:223], v212, s[20:23], s68 offen sc1
  s_add_u32 s68, s68, 18432
  s_waitcnt lgkmcnt(2)
  buffer_store_dwordx4 v[224:227], v212, s[20:23], s68 offen sc1
  s_add_u32 s68, s68, 18432
  s_waitcnt lgkmcnt(0)
  buffer_store_dwordx4 v[228:231], v212, s[20:23], s68 offen sc1
p1_kernel_sjend:
  s_branch p1_kernel_fin
p1_kernel_C:
  s_load_dwordx8 s[32:39], s[0:1], 32
  s_load_dwordx4 s[4:7], s[0:1], 80
  v_lshrrev_b32 v16, 4, v1
  v_and_b32 v17, 1, v16
  v_lshrrev_b32 v18, 1, v16
  v_and_b32 v19, 15, v1
  v_lshrrev_b32 v20, 2, v19
  v_and_b32 v21, 3, v19
  v_lshrrev_b32 v22, 1, v21
  v_lshl_add_u32 v22, v17, 1, v22
  v_and_b32 v23, 1, v21
  v_lshl_add_u32 v24, v18, 3, v20
  v_mul_u32_u24 v24, 384, v24
  v_add_u32 v24, 49152, v24
  v_lshrrev_b32 v25, 1, v20
  v_lshl_add_u32 v30, v23, 2, v22
  v_lshlrev_b32 v26, 3, v30
  v_add_u32 v26, s51, v26
  v_lshrrev_b32 v27, 6, v26
  v_and_b32 v26, 63, v26
  v_add_u32 v27, v27, v25
  v_add_u32 v27, 0, v27
  v_mov_b32 v28, 0
  v_cmp_le_u32 vcc, 6, v27
  v_subrev_u32 v29, 6, v27
  s_nop 0
  v_cndmask_b32 v27, v27, v29, vcc
  v_lshrrev_b32 v29, 4, v26
  v_xor_b32 v29, v29, v28
  v_and_b32 v26, 15, v26
  v_lshl_add_u32 v26, v29, 4, v26
  v_lshl_add_u32 v26, v27, 6, v26
  v_add_u32 v2, v24, v26
  v_lshlrev_b32 v26, 3, v30
  v_add_u32 v26, s51, v26
  v_lshrrev_b32 v27, 6, v26
  v_and_b32 v26, 63, v26
  v_add_u32 v27, v27, v25
  v_add_u32 v27, 2, v27
  v_mov_b32 v28, 0
  v_cmp_le_u32 vcc, 6, v27
  v_subrev_u32 v29, 6, v27
  s_nop 0
  v_cndmask_b32 v27, v27, v29, vcc
  v_lshrrev_b32 v29, 4, v26
  v_xor_b32 v29, v29, v28
  v_and_b32 v26, 15, v26
  v_lshl_add_u32 v26, v29, 4, v26
  v_lshl_add_u32 v26, v27, 6, v26
  v_add_u32 v3, v24, v26
  v_lshlrev_b32 v26, 3, v30
  v_add_u32 v26, s51, v26
  v_lshrrev_b32 v27, 6, v26
  v_and_b32 v26, 63, v26
  v_add_u32 v27, v27, v25
  v_add_u32 v27, 4, v27
  v_mov_b32 v28, 1
  v_cmp_le_u32 vcc, 6, v27
  v_subrev_u32 v29, 6, v27
  s_nop 0
  v_cndmask_b32 v27, v27, v29, vcc
  v_lshrrev_b32 v29, 4, v26
  v_xor_b32 v29, v29, v28
  v_and_b32 v26, 15, v26
  v_lshl_add_u32 v26, v29, 4, v26
  v_lshl_add_u32 v26, v27, 6, v26
  v_add_u32 v4, v24, v26
  v_cmp_eq_u32 vcc, 3, v22
  s_nop 1
  v_cndmask_b32 v31, v22, v23, vcc
  v_lshlrev_b32 v30, 2, v23
  v_add_u32 v30, 4, v30
  v_lshlrev_b32 v26, 3, v30
  v_add_u32 v26, s51, v26
  v_lshrrev_b32 v27, 6, v26
  v_and_b32 v26, 63, v26
  v_add_u32 v27, v27, v25
  v_lshl_add_u32 v27, v31, 1, v27
  v_lshrrev_b32 v28, 1, v31
  v_cmp_le_u32 vcc, 6, v27
  v_subrev_u32 v29, 6, v27
  s_nop 0
  v_cndmask_b32 v27, v27, v29, vcc
  v_lshrrev_b32 v29, 4, v26
  v_xor_b32 v29, v29, v28
  v_and_b32 v26, 15, v26
  v_lshl_add_u32 v26, v29, 4, v26
  v_lshl_add_u32 v26, v27, 6, v26
  v_add_u32 v5, v24, v26
  v_and_b32 v16, 31, v1
  v_lshrrev_b32 v17, 5, v1
  v_lshrrev_b32 v18, 1, v16
  v_and_b32 v18, 7, v18
  s_lshl_b32 s62, s3, 12
  v_lshlrev_b32 v19, 7, v16
  v_add_u32 v19, s62, v19
  v_add_u32 v20, 0, v17
  v_xor_b32 v20, v20, v18
  v_lshl_add_u32 v6, v20, 4, v19
  v_add_u32 v20, 2, v17
  v_xor_b32 v20, v20, v18
  v_lshl_add_u32 v7, v20, 4, v19
  v_add_u32 v20, 4, v17
  v_xor_b32 v20, v20, v18
  v_lshl_add_u32 v8, v20, 4, v19
  v_add_u32 v20, 6, v17
  v_xor_b32 v20, v20, v18
  v_lshl_add_u32 v9, v20, 4, v19
  v_mov_b32 v64, 0
  v_mov_b32 v65, 0
  v_mov_b32 v66, 0
  v_mov_b32 v67, 0
  v_mov_b32 v68, 0
  v_mov_b32 v69, 0
  v_mov_b32 v70, 0
  v_mov_b32 v71, 0
  v_mov_b32 v72, 0
  v_mov_b32 v73, 0
  v_mov_b32 v74, 0
  v_mov_b32 v75, 0
  v_mov_b32 v76, 0
  v_mov_b32 v77, 0
  v_mov_b32 v78, 0
  v_mov_b32 v79, 0
  v_mov_b32 v80, 0
  v_mov_b32 v81, 0
  v_mov_b32 v82, 0
  v_mov_b32 v83, 0
  v_mov_b32 v84, 0
  v_mov_b32 v85, 0
  v_mov_b32 v86, 0
  v_mov_b32 v87, 0
  v_mov_b32 v88, 0
  v_mov_b32 v89, 0
  v_mov_b32 v90, 0
  v_mov_b32 v91, 0
  v_mov_b32 v92, 0
  v_mov_b32 v93, 0
  v_mov_b32 v94, 0
  v_mov_b32 v95, 0
  v_mov_b32 v96, 0
  v_mov_b32 v97, 0
  v_mov_b32 v98, 0
  v_mov_b32 v99, 0
  v_mov_b32 v100, 0
  v_mov_b32 v101, 0
  v_mov_b32 v102, 0
  v_mov_b32 v103, 0
  v_mov_b32 v104, 0
  v_mov_b32 v105, 0
  v_mov_b32 v106, 0
  v_mov_b32 v107, 0
  v_mov_b32 v108, 0
  v_mov_b32 v109, 0
  v_mov_b32 v110, 0
  v_mov_b32 v111, 0
  v_mov_b32 v112, 0
  v_mov_b32 v113, 0
  v_mov_b32 v114, 0
  v_mov_b32 v115, 0
  v_mov_b32 v116, 0
  v_mov_b32 v117, 0
  v_mov_b32 v118, 0
  v_mov_b32 v119, 0
  v_mov_b32 v120, 0
  v_mov_b32 v121, 0
  v_mov_b32 v122, 0
  v_mov_b32 v123, 0
  v_mov_b32 v124, 0
  v_mov_b32 v125, 0
  v_mov_b32 v126, 0
  v_mov_b32 v127, 0
  v_mov_b32 v128, 0
  v_mov_b32 v129, 0
  v_mov_b32 v56, 0
  v_mov_b32 v57, 0
  v_mov_b32 v58, 0
  v_mov_b32 v59, 0
  v_mov_b32 v60, 0
  v_mov_b32 v61, 0
  v_mov_b32 v62, 0
  v_mov_b32 v63, 0
  s_mov_b32 s52, 0xff000000
  s_mov_b32 s53, 0xff000000
  v_mov_b32 v15, 0x3f803f80
  s_waitcnt lgkmcnt(0)
  s_mov_b32 s8, s24
  s_and_b32 s9, s25, 0xffff
  s_mov_b32 s10, 2359296
  s_mov_b32 s11, 0x20000
  s_mov_b32 s12, s26
  s_and_b32 s13, s27, 0xffff
  s_mov_b32 s14, 1990656
  s_mov_b32 s15, 0x20000
  s_mov_b32 s16, s28
  s_and_b32 s17, s29, 0xffff
  s_mov_b32 s18, 20736
  s_mov_b32 s19, 0x20000
  s_mov_b32 s20, s6
  s_and_b32 s21, s7, 0xffff
  s_mov_b32 s22, 39313408
  s_mov_b32 s23, 0x20000
  s_mov_b32 s28, s38
  s_and_b32 s29, s39, 0xffff
  s_mov_b32 s30, 5308416
  s_mov_b32 s31, 0x20000
  s_mov_b32 s24, s34
  s_and_b32 s25, s35, 0xffff
  s_mov_b32 s26, 5308416
  s_mov_b32 s27, 0x20000
  s_mov_b32 s4, s4
  s_and_b32 s5, s5, 0xffff
  s_mov_b32 s6, 256
  s_mov_b32 s7, 0x20000
  s_mov_b32 s36, 24576
  s_mov_b32 s37, 16384
  v_lshlrev_b32 v16, 4, v1
  s_mov_b32 m0, 147456
  s_mul_i32 s63, s41, 1296
  buffer_load_dwordx4 v16, s[16:19], s63 offen lds
  s_add_u32 m0, m0, 1024
  s_add_u32 s63, s63, 1024
  buffer_load_dwordx4 v16, s[16:19], s63 offen lds
  s_lshl_b32 s62, s2, 2
  s_add_u32 s62, s62, s3
  s_add_u32 s63, s62, 0
  s_mov_b32 s70, 0
  s_cmp_ge_u32 s63, 1296
  s_cselect_b32 s70, 1, 0
  s_cselect_b32 s64, 1296, 0
  s_sub_u32 s63, s63, s64
  s_cmp_ge_u32 s63, 1296
  s_cselect_b32 s64, 1296, 0
  s_cselect_b32 s65, 2, s70
  s_mov_b32 s70, s65
  s_sub_u32 s63, s63, s64
  s_mul_i32 s64, s63, 25891
  s_lshr_b32 s64, s64, 22
  s_cmp_eq_u32 s70, 2
  s_cselect_b32 s65, s64, 0
  s_cmp_ge_u32 s65, 1
  s_cselect_b32 s70, 3, s70
  s_mul_i32 s65, s64, 162
  s_sub_u32 s63, s63, s65
  s_mul_i32 s65, s63, 7282
  s_lshr_b32 s65, s65, 16
  s_mul_i32 s76, s65, 9
  s_sub_u32 s63, s63, s76
  s_mul_i32 s76, s64, 36
  s_lshl_b32 s77, s63, 2
  s_add_u32 s76, s76, s77
  s_mul_i32 s76, s76, 18
  s_add_u32 s76, s76, s65
  s_lshl_b32 s76, s76, 10
  s_mov_b32 s77, 0
  s_cmp_eq_u32 s70, 1
  s_cselect_b32 s77, 5308416, s77
  s_cmp_eq_u32 s70, 2
  s_cselect_b32 s77, 10616832, s77
  s_add_u32 s66, s76, s77
  s_lshl_b32 s63, s63, 7
  s_mul_i32 s76, s65, 294912
  s_mul_i32 s77, s64, 1152
  s_add_u32 s76, s76, s77
  s_add_u32 s76, s76, s63
  s_mul_i32 s77, s64, 576
  s_lshl_b32 s65, s65, 5
  s_add_u32 s77, s77, s65
  s_mul_i32 s77, s77, 1152
  s_add_u32 s77, s77, s63
  s_cmp_eq_u32 s70, 0
  s_cselect_b32 s76, s76, s77
  s_cmp_eq_u32 s70, 2
  s_cselect_b32 s73, s63, s76
  s_add_u32 s63, s62, 1024
  s_mov_b32 s71, 0
  s_cmp_ge_u32 s63, 1296
  s_cselect_b32 s71, 1, 0
  s_cselect_b32 s64, 1296, 0
  s_sub_u32 s63, s63, s64
  s_cmp_ge_u32 s63, 1296
  s_cselect_b32 s64, 1296, 0
  s_cselect_b32 s65, 2, s71
  s_mov_b32 s71, s65
  s_sub_u32 s63, s63, s64
  s_mul_i32 s64, s63, 25891
  s_lshr_b32 s64, s64, 22
  s_cmp_eq_u32 s71, 2
  s_cselect_b32 s65, s64, 0
  s_cmp_ge_u32 s65, 1
  s_cselect_b32 s71, 3, s71
  s_mul_i32 s65, s64, 162
  s_sub_u32 s63, s63, s65
  s_mul_i32 s65, s63, 7282
  s_lshr_b32 s65, s65, 16
  s_mul_i32 s76, s65, 9
  s_sub_u32 s63, s63, s76
  s_mul_i32 s76, s64, 36
  s_lshl_b32 s77, s63, 2
  s_add_u32 s76, s76, s77
  s_mul_i32 s76, s76, 18
  s_add_u32 s76, s76, s65
  s_lshl_b32 s76, s76, 10
  s_mov_b32 s77, 0
  s_cmp_eq_u32 s71, 1
  s_cselect_b32 s77, 5308416, s77
  s_cmp_eq_u32 s71, 2
  s_cselect_b32 s77, 10616832, s77
  s_add_u32 s67, s76, s77
  s_lshl_b32 s63, s63, 7
  s_mul_i32 s76, s65, 294912
  s_mul_i32 s77, s64, 1152
  s_add_u32 s76, s76, s77
  s_add_u32 s76, s76, s63
  s_mul_i32 s77, s64, 576
  s_lshl_b32 s65, s65, 5
  s_add_u32 s77, s77, s65
  s_mul_i32 s77, s77, 1152
  s_add_u32 s77, s77, s63
  s_cmp_eq_u32 s71, 0
  s_cselect_b32 s76, s76, s77
  s_cmp_eq_u32 s71, 2
  s_cselect_b32 s74, s63, s76
  s_add_u32 s63, s62, 2048
  s_mov_b32 s72, 0
  s_cmp_ge_u32 s63, 1296
  s_cselect_b32 s72, 1, 0
  s_cselect_b32 s64, 1296, 0
  s_sub_u32 s63, s63, s64
  s_cmp_ge_u32 s63, 1296
  s_cselect_b32 s64, 1296, 0
  s_cselect_b32 s65, 2, s72
  s_mov_b32 s72, s65
  s_sub_u32 s63, s63, s64
  s_mul_i32 s64, s63, 25891
  s_lshr_b32 s64, s64, 22
  s_cmp_eq_u32 s72, 2
  s_cselect_b32 s65, s64, 0
  s_cmp_ge_u32 s65, 1
  s_cselect_b32 s72, 3, s72
  s_mul_i32 s65, s64, 162
  s_sub_u32 s63, s63, s65
  s_mul_i32 s65, s63, 7282
  s_lshr_b32 s65, s65, 16
  s_mul_i32 s76, s65, 9
  s_sub_u32 s63, s63, s76
  s_mov_b32 s69, s65
  s_mul_i32 s76, s64, 36
  s_lshl_b32 s77, s63, 2
  s_add_u32 s76, s76, s77
  s_mul_i32 s76, s76, 18
  s_add_u32 s76, s76, s65
  s_lshl_b32 s76, s76, 10
  s_mov_b32 s77, 0
  s_cmp_eq_u32 s72, 1
  s_cselect_b32 s77, 5308416, s77
  s_cmp_eq_u32 s72, 2
  s_cselect_b32 s77, 10616832, s77
  s_add_u32 s68, s76, s77
  s_lshl_b32 s63, s63, 7
  s_mul_i32 s76, s65, 294912
  s_mul_i32 s77, s64, 1152
  s_add_u32 s76, s76, s77
  s_add_u32 s76, s76, s63
  s_mul_i32 s77, s64, 576
  s_lshl_b32 s65, s65, 5
  s_add_u32 s77, s77, s65
  s_mul_i32 s77, s77, 1152
  s_add_u32 s77, s77, s63
  s_cmp_eq_u32 s72, 0
  s_cselect_b32 s76, s76, s77
  s_cmp_eq_u32 s72, 2
  s_cselect_b32 s75, s63, s76
  v_and_b32 v20, 31, v1
  v_mul_u32_u24 v12, 9216, v20
  v_mul_u32_u24 v42, 1152, v20
  v_mov_b32 v23, 0x7fff0000
  v_cmp_gt_u32 vcc, 32, v1
  s_nop 1
  v_cndmask_b32 v12, v23, v12, vcc
  v_cndmask_b32 v42, v23, v42, vcc
  v_mov_b32 v136, 0
  v_mov_b32 v137, 0
  v_mov_b32 v138, 0
  v_mov_b32 v139, 0
  v_mov_b32 v140, 0
  v_mov_b32 v141, 0
  v_mov_b32 v142, 0
  v_mov_b32 v143, 0
  v_mov_b32 v144, 0
  v_mov_b32 v145, 0
  v_mov_b32 v146, 0
  v_mov_b32 v147, 0
  v_mov_b32 v148, 0
  v_mov_b32 v149, 0
  v_mov_b32 v150, 0
  v_mov_b32 v151, 0
  v_mov_b32 v152, 0
  v_mov_b32 v153, 0
  v_mov_b32 v154, 0
  v_mov_b32 v155, 0
  v_mov_b32 v156, 0
  v_mov_b32 v157, 0
  v_mov_b32 v158, 0
  v_mov_b32 v159, 0
  v_and_b32 v16, 31, v1
  v_lshrrev_b32 v17, 3, v16
  v_and_b32 v18, 3, v16
  v_lshl_add_u32 v17, v17, 2, v18
  v_lshrrev_b32 v18, 5, v1
  v_mul_u32_u24 v19, 576, v18
  v_lshl_add_u32 v19, v17, 1, v19
  v_add_u32 v19, 147456, v19
  v_writelane_b32 v20, s70, 0
  v_writelane_b32 v20, s71, 1
  v_writelane_b32 v20, s72, 2
  v_writelane_b32 v20, s73, 3
  v_writelane_b32 v20, s74, 4
  v_writelane_b32 v20, s75, 5
  v_writelane_b32 v20, s66, 6
  v_writelane_b32 v20, s67, 7
  v_writelane_b32 v20, s68, 8
  v_writelane_b32 v20, s69, 9
  v_lshlrev_b32 v21, 2, v1
  s_lshl_b32 s62, s3, 6
  s_add_u32 s62, s62, 156160
  v_add_u32 v21, s62, v21
  s_mov_b32 exec_lo, 0x3ff
  s_mov_b32 exec_hi, 0x0
  ds_write_b32 v21, v20
  s_mov_b64 exec, -1
  s_waitcnt vmcnt(0)
  s_mov_b32 exec_lo, 0xf0f0f0f
  s_mov_b32 exec_hi, 0x0
  ds_read_u16 v160, v19 offset:0
  ds_read_u16 v161, v19 offset:36
  s_mov_b32 exec_lo, 0xf0f0f0f
  s_mov_b32 exec_hi, 0xf0f0f0f0
  ds_read_u16 v162, v19 offset:72
  ds_read_u16 v163, v19 offset:108
  ds_read_u16 v164, v19 offset:144
  ds_read_u16 v165, v19 offset:180
  ds_read_u16 v166, v19 offset:216
  ds_read_u16 v167, v19 offset:252
  ds_read_u16 v168, v19 offset:288
  ds_read_u16 v169, v19 offset:324
  ds_read_u16 v170, v19 offset:360
  ds_read_u16 v171, v19 offset:396
  ds_read_u16 v172, v19 offset:432
  ds_read_u16 v173, v19 offset:468
  ds_read_u16 v174, v19 offset:504
  ds_read_u16 v175, v19 offset:540
  ds_read_u16 v176, v19 offset:576
  ds_read_u16 v177, v19 offset:612
  s_mov_b32 exec_lo, 0x0
  s_mov_b32 exec_hi, 0xf0f0f0f0
  ds_read_u16 v178, v19 offset:648
  ds_read_u16 v179, v19 offset:684
  s_mov_b32 exec_lo, 0x3
  s_mov_b32 exec_hi, 0x0
  ds_read_u16 v180, v19 offset:32
  ds_read_u16 v181, v19 offset:68
  s_mov_b32 exec_lo, 0x3
  s_mov_b32 exec_hi, 0x30
  ds_read_u16 v182, v19 offset:104
  ds_read_u16 v183, v19 offset:140
  ds_read_u16 v184, v19 offset:176
  ds_read_u16 v185, v19 offset:212
  ds_read_u16 v186, v19 offset:248
  ds_read_u16 v187, v19 offset:284
  ds_read_u16 v188, v19 offset:320
  ds_read_u16 v189, v19 offset:356
  ds_read_u16 v190, v19 offset:392
  ds_read_u16 v191, v19 offset:428
  ds_read_u16 v192, v19 offset:464
  ds_read_u16 v193, v19 offset:500
  ds_read_u16 v194, v19 offset:536
  ds_read_u16 v195, v19 offset:572
  ds_read_u16 v196, v19 offset:608
  ds_read_u16 v197, v19 offset:644
  s_mov_b32 exec_lo, 0x0
  s_mov_b32 exec_hi, 0x30
  ds_read_u16 v198, v19 offset:680
  ds_read_u16 v199, v19 offset:716
  s_waitcnt lgkmcnt(0)
  s_mov_b32 exec_lo, 0xf0f0f0f
  s_mov_b32 exec_hi, 0x0
  v_lshl_or_b32 v136, v161, 16, v160
  s_mov_b32 exec_lo, 0xf0f0f0f
  s_mov_b32 exec_hi, 0xf0f0f0f0
  v_lshl_or_b32 v137, v163, 16, v162
  v_lshl_or_b32 v138, v165, 16, v164
  v_lshl_or_b32 v139, v167, 16, v166
  v_lshl_or_b32 v140, v169, 16, v168
  v_lshl_or_b32 v141, v171, 16, v170
  v_lshl_or_b32 v142, v173, 16, v172
  v_lshl_or_b32 v143, v175, 16, v174
  v_lshl_or_b32 v144, v177, 16, v176
  s_mov_b32 exec_lo, 0x0
  s_mov_b32 exec_hi, 0xf0f0f0f0
  v_lshl_or_b32 v145, v179, 16, v178
  s_mov_b32 exec_lo, 0x3
  s_mov_b32 exec_hi, 0x0
  v_lshl_or_b32 v148, v181, 16, v180
  s_mov_b32 exec_lo, 0x3
  s_mov_b32 exec_hi, 0x30
  v_lshl_or_b32 v149, v183, 16, v182
  v_lshl_or_b32 v150, v185, 16, v184
  v_lshl_or_b32 v151, v187, 16, v186
  v_lshl_or_b32 v152, v189, 16, v188
  v_lshl_or_b32 v153, v191, 16, v190
  v_lshl_or_b32 v154, v193, 16, v192
  v_lshl_or_b32 v155, v195, 16, v194
  v_lshl_or_b32 v156, v197, 16, v196
  s_mov_b32 exec_lo, 0x0
  s_mov_b32 exec_hi, 0x30
  v_lshl_or_b32 v157, v199, 16, v198
  s_mov_b64 exec, -1
  s_cmp_eq_u32 s3, 0
  s_cbranch_scc0 p1_kernel_nwf
  v_lshlrev_b32 v16, 4, v1
  v_add_u32 v16, 150016, v16
  ds_write_b128 v16, v[136:139] offset:0
  ds_write_b128 v16, v[140:143] offset:1024
  ds_write_b128 v16, v[144:147] offset:2048
  ds_write_b128 v16, v[148:151] offset:3072
  ds_write_b128 v16, v[152:155] offset:4096
  ds_write_b128 v16, v[156:159] offset:5120
p1_kernel_nwf:
  s_mul_i32 s62, s3, 3072
  s_add_u32 s62, s62, 49152
  v_lshlrev_b32 v43, 4, v1
  v_add_u32 v43, s62, v43
  v_lshrrev_b32 v10, 5, v1
  v_lshlrev_b32 v10, 4, v10
  v_add_u32 v10, 149504, v10
  v_and_b32 v20, 31, v1
  s_lshl_b32 s62, s3, 5
  v_add_u32 v20, s62, v20
  v_lshrrev_b32 v21, 5, v1
  v_mul_u32_u24 v42, 48, v20
  v_mul_u32_u24 v22, 6144, v21
  v_add3_u32 v42, v42, v22, 0
  v_add_u32 v42, 20480, v42
  v_mul_u32_u24 v41, 80, v20
  v_mul_u32_u24 v22, 10240, v21
  v_add_u32 v41, v41, v22
  v_lshrrev_b32 v16, 4, v1
  v_and_b32 v17, 15, v1
  v_lshrrev_b32 v18, 2, v17
  v_lshl_add_u32 v18, v16, 2, v18
  v_and_b32 v19, 3, v17
  v_lshlrev_b32 v19, 3, v19
  s_and_b32 s64, s3, 1
  s_lshr_b32 s65, s3, 1
  s_mul_i32 s62, s64, 6144
  s_lshl_b32 s63, s65, 5
  s_add_u32 s62, s62, s63
  s_add_u32 s62, s62, 20480
  v_mul_u32_u24 v40, 48, v18
  v_add3_u32 v40, v40, v19, s62
  s_mul_i32 s62, s64, 10240
  v_mul_u32_u24 v11, 80, v18
  v_add3_u32 v11, v11, v19, s62
  s_lshl_b32 s63, s65, 4
  v_lshl_add_u32 v22, v16, 2, s63
  v_lshrrev_b32 v23, 2, v17
  v_mul_u32_u24 v23, 192, v23
  v_and_b32 v24, 3, v17
  v_add_u32 v23, v23, v24
  v_lshrrev_b32 v25, 1, v17
  v_mul_u32_u24 v25, 48, v25
  v_and_b32 v24, 1, v17
  v_add_u32 v25, v25, v24
  v_add_u32 v25, 768, v25
  s_mul_i32 s62, s64, 864
  v_add_u32 v23, s62, v23
  v_add_u32 v25, s62, v25
  v_add_u32 v26, 0, v22
  v_cmp_le_u32 vcc, 10, v26
  v_add_u32 v27, 2, v26
  s_nop 0
  v_cndmask_b32 v26, v26, v27, vcc
  v_lshl_add_u32 v130, v26, 2, v23
  v_lshlrev_b32 v130, 2, v130
  v_add_u32 v130, 36864, v130
  v_lshl_add_u32 v134, v26, 1, v25
  v_lshlrev_b32 v134, 2, v134
  v_add_u32 v134, 36864, v134
  v_add_u32 v26, 1, v22
  v_cmp_le_u32 vcc, 10, v26
  v_add_u32 v27, 2, v26
  s_nop 0
  v_cndmask_b32 v26, v26, v27, vcc
  v_lshl_add_u32 v131, v26, 2, v23
  v_lshlrev_b32 v131, 2, v131
  v_add_u32 v131, 36864, v131
  v_lshl_add_u32 v135, v26, 1, v25
  v_lshlrev_b32 v135, 2, v135
  v_add_u32 v135, 36864, v135
  v_add_u32 v26, 2, v22
  v_cmp_le_u32 vcc, 10, v26
  v_add_u32 v27, 2, v26
  s_nop 0
  v_cndmask_b32 v26, v26, v27, vcc
  v_lshl_add_u32 v132, v26, 2, v23
  v_lshlrev_b32 v132, 2, v132
  v_add_u32 v132, 36864, v132
  v_lshl_add_u32 v160, v26, 1, v25
  v_lshlrev_b32 v160, 2, v160
  v_add_u32 v160, 36864, v160
  v_add_u32 v26, 3, v22
  v_cmp_le_u32 vcc, 10, v26
  v_add_u32 v27, 2, v26
  s_nop 0
  v_cndmask_b32 v26, v26, v27, vcc
  v_lshl_add_u32 v133, v26, 2, v23
  v_lshlrev_b32 v133, 2, v133
  v_add_u32 v133, 36864, v133
  v_lshl_add_u32 v161, v26, 1, v25
  v_lshlrev_b32 v161, 2, v161
  v_add_u32 v161, 36864, v161
  v_lshlrev_b32 v163, 2, v0
  v_add_u32 v162, 36864, v163
  v_cmp_gt_u32 vcc, 192, v0
  v_mov_b32 v12, 0x7fff0000
  s_nop 0
  v_cndmask_b32 v12, v12, v163, vcc
  s_cmp_eq_u32 s65, 0
  s_cselect_b32 s46, -1, 0xffff
  s_cselect_b32 s47, -1, 0
  s_cselect_b32 s48, 0x000f000f, 0xf
  s_cselect_b32 s49, 0x000f000f, 0
  s_mul_i32 s45, s41, 6912
  s_add_u32 s45, s45, 37232640
  s_waitcnt lgkmcnt(0)
  s_barrier
  ds_read_b128 v[48:51], v6
  ds_read_b64_tr_b16 v[176:177], v2 offset:0
  ds_read_b64_tr_b16 v[178:179], v2 offset:1536
  ds_read_b64_tr_b16 v[180:181], v3 offset:0
  ds_read_b64_tr_b16 v[182:183], v3 offset:1536
  ds_read_b64_tr_b16 v[184:185], v4 offset:0
  ds_read_b64_tr_b16 v[186:187], v4 offset:1536
  ds_read_b64_tr_b16 v[188:189], v5 offset:0
  ds_read_b64_tr_b16 v[190:191], v5 offset:1536
  ds_read_b128 v[52:55], v7
  ds_read_b64_tr_b16 v[192:193], v2 offset:6144
  ds_read_b64_tr_b16 v[194:195], v2 offset:7680
  ds_read_b64_tr_b16 v[196:197], v3 offset:6144
  ds_read_b64_tr_b16 v[198:199], v3 offset:7680
  ds_read_b64_tr_b16 v[200:201], v4 offset:6144
  ds_read_b64_tr_b16 v[202:203], v4 offset:7680
  ds_read_b64_tr_b16 v[204:205], v5 offset:6144
  ds_read_b64_tr_b16 v[206:207], v5 offset:7680
  s_getpc_b64 s[62:63]
p1_kernel_cpf0:
  s_sub_u32 s62, s62, p1_kernel_cpf0-p1_kernel_hl
  s_subb_u32 s63, s63, 0
  v_lshlrev_b32 v33, 7, v1
  v_add_u32 v33, 0, v33
  v_cmp_gt_u32 vcc, p2_kernel-p1_kernel_hl, v33
  v_mov_b32 v34, 0
  s_nop 0
  v_cndmask_b32 v33, v34, v33, vcc
  global_load_dword v34, v33, s[62:63]
  v_lshlrev_b32 v33, 7, v1
  v_add_u32 v33, 8192, v33
  v_cmp_gt_u32 vcc, p2_kernel-p1_kernel_hl, v33
  v_mov_b32 v34, 0
  s_nop 0
  v_cndmask_b32 v33, v34, v33, vcc
  global_load_dword v34, v33, s[62:63]
  s_mov_b32 s44, 0
  s_mov_b32 s56, 0
  s_mov_b32 s57, 0
p1_kernel_loop:
  s_waitcnt lgkmcnt(9)
  v_dot2c_f32_bf16 v128, v56, v56
  v_dot2c_f32_bf16 v129, v57, v57
  v_dot2c_f32_bf16 v128, v58, v58
  v_dot2c_f32_bf16 v129, v59, v59
  v_dot2c_f32_bf16 v128, v60, v60
  v_dot2c_f32_bf16 v129, v61, v61
  v_dot2c_f32_bf16 v128, v62, v62
  v_dot2c_f32_bf16 v129, v63, v63
  v_mfma_f32_32x32x16_bf16 v[64:79], v[176:179], v[48:51], v[64:79]
  ds_read_b128 v[56:59], v8
  ds_read_b64_tr_b16 v[208:209], v2 offset:12288
  ds_read_b64_tr_b16 v[210:211], v2 offset:13824
  v_cndmask_b32 v188, v188, v15, s[52:53]
  v_cndmask_b32 v189, v189, v15, s[52:53]
  v_mfma_f32_32x32x16_bf16 v[80:95], v[180:183], v[48:51], v[80:95]
  ds_read_b64_tr_b16 v[212:213], v3 offset:12288
  ds_read_b64_tr_b16 v[214:215], v3 offset:13824
  ds_read_b64_tr_b16 v[216:217], v4 offset:12288
  v_cndmask_b32 v190, v190, v15, s[52:53]
  v_cndmask_b32 v191, v191, v15, s[52:53]
  v_mfma_f32_32x32x16_bf16 v[96:111], v[184:187], v[48:51], v[96:111]
  ds_read_b64_tr_b16 v[218:219], v4 offset:13824
  ds_read_b64_tr_b16 v[220:221], v5 offset:12288
  ds_read_b64_tr_b16 v[222:223], v5 offset:13824
  v_mfma_f32_32x32x16_bf16 v[112:127], v[188:191], v[48:51], v[112:127]
  s_waitcnt lgkmcnt(9)
  v_mfma_f32_32x32x16_bf16 v[64:79], v[192:195], v[52:55], v[64:79]
  ds_read_b128 v[60:63], v9
  ds_read_b64_tr_b16 v[224:225], v2 offset:18432
  ds_read_b64_tr_b16 v[226:227], v2 offset:19968
  v_cndmask_b32 v204, v204, v15, s[52:53]
  v_cndmask_b32 v205, v205, v15, s[52:53]
  v_mfma_f32_32x32x16_bf16 v[80:95], v[196:199], v[52:55], v[80:95]
  ds_read_b64_tr_b16 v[228:229], v3 offset:18432
  ds_read_b64_tr_b16 v[230:231], v3 offset:19968
  ds_read_b64_tr_b16 v[232:233], v4 offset:18432
  v_cndmask_b32 v206, v206, v15, s[52:53]
  v_cndmask_b32 v207, v207, v15, s[52:53]
  v_mfma_f32_32x32x16_bf16 v[96:111], v[200:203], v[52:55], v[96:111]
  ds_read_b64_tr_b16 v[234:235], v4 offset:19968
  ds_read_b64_tr_b16 v[236:237], v5 offset:18432
  ds_read_b64_tr_b16 v[238:239], v5 offset:19968
  v_mfma_f32_32x32x16_bf16 v[112:127], v[204:207], v[52:55], v[112:127]
  s_waitcnt lgkmcnt(9)
  v_dot2c_f32_bf16 v128, v48, v48
  v_dot2c_f32_bf16 v129, v49, v49
  v_dot2c_f32_bf16 v128, v50, v50
  v_dot2c_f32_bf16 v129, v51, v51
  v_dot2c_f32_bf16 v128, v52, v52
  v_dot2c_f32_bf16 v129, v53, v53
  v_dot2c_f32_bf16 v128, v54, v54
  v_dot2c_f32_bf16 v129, v55, v55
  v_mfma_f32_32x32x16_bf16 v[64:79], v[208:211], v[56:59], v[64:79]
  s_add_u32 s57, s57, 1
  s_cmp_eq_u32 s57, 4
  s_cselect_b32 s59, 0xfffee000, s36
  s_cselect_b32 s57, 0, s57
  s_add_u32 s56, s56, 1
  s_cmp_eq_u32 s56, 3
  s_cselect_b32 s58, 0xffff8000, s37
  s_cselect_b32 s56, 0, s56
  v_mfma_f32_32x32x16_bf16 v[80:95], v[212:215], v[56:59], v[80:95]
  v_add_u32 v2, s59, v2
  v_add_u32 v3, s59, v3
  v_add_u32 v4, s59, v4
  v_add_u32 v5, s59, v5
  v_add_u32 v6, s58, v6
  v_add_u32 v7, s58, v7
  v_add_u32 v8, s58, v8
  v_add_u32 v9, s58, v9
  v_cndmask_b32 v220, v220, v15, s[52:53]
  v_cndmask_b32 v221, v221, v15, s[52:53]
  v_cndmask_b32 v222, v222, v15, s[52:53]
  v_cndmask_b32 v223, v223, v15, s[52:53]
  s_waitcnt lgkmcnt(0)
  s_barrier
  v_mfma_f32_32x32x16_bf16 v[96:111], v[216:219], v[56:59], v[96:111]
  ds_read_b128 v[48:51], v6
  ds_read_b64_tr_b16 v[176:177], v2 offset:0
  ds_read_b64_tr_b16 v[178:179], v2 offset:1536
  ds_read_b64_tr_b16 v[180:181], v3 offset:0
  ds_read_b64_tr_b16 v[182:183], v3 offset:1536
  v_mfma_f32_32x32x16_bf16 v[112:127], v[220:223], v[56:59], v[112:127]
  ds_read_b64_tr_b16 v[184:185], v4 offset:0
  ds_read_b64_tr_b16 v[186:187], v4 offset:1536
  ds_read_b64_tr_b16 v[188:189], v5 offset:0
  ds_read_b64_tr_b16 v[190:191], v5 offset:1536
  s_waitcnt lgkmcnt(9)
  v_mfma_f32_32x32x16_bf16 v[64:79], v[224:227], v[60:63], v[64:79]
  ds_read_b128 v[52:55], v7
  ds_read_b64_tr_b16 v[192:193], v2 offset:6144
  ds_read_b64_tr_b16 v[194:195], v2 offset:7680
  v_cndmask_b32 v236, v236, v15, s[52:53]
  v_cndmask_b32 v237, v237, v15, s[52:53]
  v_mfma_f32_32x32x16_bf16 v[80:95], v[228:231], v[60:63], v[80:95]
  ds_read_b64_tr_b16 v[196:197], v3 offset:6144
  ds_read_b64_tr_b16 v[198:199], v3 offset:7680
  ds_read_b64_tr_b16 v[200:201], v4 offset:6144
  v_cndmask_b32 v238, v238, v15, s[52:53]
  v_cndmask_b32 v239, v239, v15, s[52:53]
  v_mfma_f32_32x32x16_bf16 v[96:111], v[232:235], v[60:63], v[96:111]
  ds_read_b64_tr_b16 v[202:203], v4 offset:7680
  ds_read_b64_tr_b16 v[204:205], v5 offset:6144
  ds_read_b64_tr_b16 v[206:207], v5 offset:7680
  v_mfma_f32_32x32x16_bf16 v[112:127], v[236:239], v[60:63], v[112:127]
  s_add_u32 s44, s44, 1
  s_cmp_lt_u32 s44, 9
  s_cbranch_scc1 p1_kernel_loop
p1_kernel_epi:
  s_waitcnt vmcnt(0) lgkmcnt(0)
  v_dot2c_f32_bf16 v128, v56, v56
  v_dot2c_f32_bf16 v129, v57, v57
  v_dot2c_f32_bf16 v128, v58, v58
  v_dot2c_f32_bf16 v129, v59, v59
  v_dot2c_f32_bf16 v128, v60, v60
  v_dot2c_f32_bf16 v129, v61, v61
  v_dot2c_f32_bf16 v128, v62, v62
  v_dot2c_f32_bf16 v129, v63, v63
  s_nop 3
  v_add_f32 v128, v128, v129
  v_mov_b32 v164, v128
  v_mul_f32 v165, 0x3ae38e39, v124
  s_nop 0
  v_permlane32_swap_b32 v128, v164
  s_nop 1
  v_add_f32 v128, v128, v164
  v_mul_f32 v166, 0x3ae38e39, v128
  v_fma_f32 v166, -v165, v165, v166
  v_max_f32 v166, 0, v166
  v_add_f32 v166, 0x3727c5ac, v166
  v_rsq_f32 v166, v166
  v_sub_f32 v167, 0, v165
  v_mul_f32 v46, 0x3fb8aa3b, v166
  v_mul_f32 v47, 0xbfb8aa3b, v166
  s_barrier
  s_lshl_b32 s62, s41, 2
  v_mov_b32 v14, 0
  buffer_load_dword v13, v14, s[4:7], s62 offen sc0 sc1
  ds_read_b128 v[168:171], v10 offset:0
  ds_read_b128 v[172:175], v10 offset:32
  ds_read_b128 v[176:179], v10 offset:64
  ds_read_b128 v[180:183], v10 offset:96
  ds_read_b128 v[216:219], v10 offset:384
  ds_read_b128 v[184:187], v10 offset:128
  ds_read_b128 v[188:191], v10 offset:160
  ds_read_b128 v[192:195], v10 offset:192
  ds_read_b128 v[196:199], v10 offset:224
  ds_read_b128 v[220:223], v10 offset:416
  ds_read_b128 v[200:203], v10 offset:256
  ds_read_b128 v[204:207], v10 offset:288
  ds_read_b128 v[208:211], v10 offset:320
  ds_read_b128 v[212:215], v10 offset:352
  ds_read_b128 v[224:227], v10 offset:448
  s_waitcnt lgkmcnt(10)
  v_fma_f32 v64, v167, v168, v64
  v_fma_f32 v65, v167, v169, v65
  v_fma_f32 v66, v167, v170, v66
  v_fma_f32 v67, v167, v171, v67
  v_fma_f32 v68, v167, v172, v68
  v_fma_f32 v69, v167, v173, v69
  v_fma_f32 v70, v167, v174, v70
  v_fma_f32 v71, v167, v175, v71
  v_fma_f32 v72, v167, v176, v72
  v_fma_f32 v73, v167, v177, v73
  v_fma_f32 v74, v167, v178, v74
  v_fma_f32 v75, v167, v179, v75
  v_fma_f32 v76, v167, v180, v76
  v_fma_f32 v77, v167, v181, v77
  v_fma_f32 v78, v167, v182, v78
  v_fma_f32 v79, v167, v183, v79
  v_fma_f32 v112, v167, v216, v112
  v_fma_f32 v113, v167, v217, v113
  v_fma_f32 v114, v167, v218, v114
  v_fma_f32 v115, v167, v219, v115
  v_cvt_pk_bf16_f32 v16, v64, v65
  v_cvt_pk_bf16_f32 v17, v66, v67
  v_cvt_pk_bf16_f32 v18, v68, v69
  v_cvt_pk_bf16_f32 v19, v70, v71
  v_cvt_pk_bf16_f32 v20, v72, v73
  v_cvt_pk_bf16_f32 v21, v74, v75
  v_cvt_pk_bf16_f32 v22, v76, v77
  v_cvt_pk_bf16_f32 v23, v78, v79
  v_cvt_pk_bf16_f32 v24, v112, v113
  v_cvt_pk_bf16_f32 v25, v114, v115
  v_mov_b32 v26, v46
  v_mov_b32 v27, v47
  ds_write_b128 v43, v[16:19] offset:0
  ds_write_b128 v43, v[20:23] offset:1024
  ds_write_b128 v43, v[24:27] offset:2048
  s_waitcnt lgkmcnt(0)
  s_barrier
  v_fma_f32 v80, v167, v184, v80
  v_fma_f32 v81, v167, v185, v81
  v_fma_f32 v82, v167, v186, v82
  v_fma_f32 v83, v167, v187, v83
  v_fma_f32 v84, v167, v188, v84
  v_fma_f32 v85, v167, v189, v85
  v_fma_f32 v86, v167, v190, v86
  v_fma_f32 v87, v167, v191, v87
  v_fma_f32 v88, v167, v192, v88
  v_fma_f32 v89, v167, v193, v89
  v_fma_f32 v90, v167, v194, v90
  v_fma_f32 v91, v167, v195, v91
  v_fma_f32 v92, v167, v196, v92
  v_fma_f32 v93, v167, v197, v93
  v_fma_f32 v94, v167, v198, v94
  v_fma_f32 v95, v167, v199, v95
  v_fma_f32 v116, v167, v220, v116
  v_fma_f32 v117, v167, v221, v117
  v_fma_f32 v118, v167, v222, v118
  v_fma_f32 v119, v167, v223, v119
  v_cvt_pk_bf16_f32 v28, v80, v81
  v_cvt_pk_bf16_f32 v29, v82, v83
  v_cvt_pk_bf16_f32 v30, v84, v85
  v_cvt_pk_bf16_f32 v31, v86, v87
  v_cvt_pk_bf16_f32 v32, v88, v89
  v_cvt_pk_bf16_f32 v33, v90, v91
  v_cvt_pk_bf16_f32 v34, v92, v93
  v_cvt_pk_bf16_f32 v35, v94, v95
  v_cvt_pk_bf16_f32 v36, v116, v117
  v_cvt_pk_bf16_f32 v37, v118, v119
  v_mov_b32 v38, 0
  v_mov_b32 v39, 0
  s_nop 1
  v_mfma_f32_32x32x16_bf16 v[240:255], v[136:139], v[28:31], 0
  v_mfma_f32_32x32x16_bf16 v[240:255], v[140:143], v[32:35], v[240:255]
  v_mfma_f32_32x32x16_bf16 v[240:255], v[144:147], v[36:39], v[240:255]
  v_mfma_f32_32x32x16_bf16 v[80:95], v[148:151], v[28:31], 0
  v_mfma_f32_32x32x16_bf16 v[80:95], v[152:155], v[32:35], v[80:95]
  v_mfma_f32_32x32x16_bf16 v[80:95], v[156:159], v[36:39], v[80:95]
  v_fma_f32 v96, v167, v200, v96
  v_fma_f32 v97, v167, v201, v97
  v_fma_f32 v98, v167, v202, v98
  v_fma_f32 v99, v167, v203, v99
  v_fma_f32 v100, v167, v204, v100
  v_fma_f32 v101, v167, v205, v101
  v_fma_f32 v102, v167, v206, v102
  v_fma_f32 v103, v167, v207, v103
  v_fma_f32 v104, v167, v208, v104
  v_fma_f32 v105, v167, v209, v105
  v_fma_f32 v106, v167, v210, v106
  v_fma_f32 v107, v167, v211, v107
  v_fma_f32 v108, v167, v212, v108
  v_fma_f32 v109, v167, v213, v109
  v_fma_f32 v110, v167, v214, v110
  v_fma_f32 v111, v167, v215, v111
  v_fma_f32 v120, v167, v224, v120
  v_fma_f32 v121, v167, v225, v121
  v_fma_f32 v122, v167, v226, v122
  v_fma_f32 v123, v167, v227, v123
  v_mul_f32 v96, v96, v166
  v_mul_f32 v97, v97, v166
  v_mul_f32 v98, v98, v166
  v_mul_f32 v99, v99, v166
  v_mul_f32 v100, v100, v166
  v_mul_f32 v101, v101, v166
  v_mul_f32 v102, v102, v166
  v_mul_f32 v103, v103, v166
  v_mul_f32 v104, v104, v166
  v_mul_f32 v105, v105, v166
  v_mul_f32 v106, v106, v166
  v_mul_f32 v107, v107, v166
  v_mul_f32 v108, v108, v166
  v_mul_f32 v109, v109, v166
  v_mul_f32 v110, v110, v166
  v_mul_f32 v111, v111, v166
  v_mul_f32 v120, v120, v166
  v_mul_f32 v121, v121, v166
  v_mul_f32 v122, v122, v166
  v_mul_f32 v123, v123, v166
  s_mov_b32 s62, 0
  s_mov_b32 s63, -1
  v_cndmask_b32 v184, v96, v98, s[62:63]
  v_cndmask_b32 v185, v97, v99, s[62:63]
  v_cndmask_b32 v186, v98, v100, s[62:63]
  v_cndmask_b32 v187, v99, v101, s[62:63]
  v_cndmask_b32 v188, v100, v102, s[62:63]
  v_cndmask_b32 v189, v101, v103, s[62:63]
  v_cndmask_b32 v190, v102, v104, s[62:63]
  v_cndmask_b32 v191, v103, v105, s[62:63]
  v_cndmask_b32 v192, v104, v106, s[62:63]
  v_mov_b32 v193, 1.0
  v_cndmask_b32 v194, v105, v107, s[62:63]
  v_cndmask_b32 v195, v106, v108, s[62:63]
  v_cndmask_b32 v196, v107, v109, s[62:63]
  v_cndmask_b32 v197, v108, v110, s[62:63]
  v_cndmask_b32 v198, v109, v111, s[62:63]
  v_cndmask_b32 v199, v110, v120, s[62:63]
  v_cndmask_b32 v200, v111, v121, s[62:63]
  v_cndmask_b32 v201, v120, v122, s[62:63]
  v_cndmask_b32 v202, v121, v123, s[62:63]
  v_mov_b32 v203, 1.0
  v_cvt_pk_bf16_f32 v204, v184, v185
  v_cvt_pk_bf16_f32 v205, v186, v187
  v_cvt_pk_bf16_f32 v206, v188, v189
  v_cvt_pk_bf16_f32 v207, v190, v191
  v_cvt_pk_bf16_f32 v208, v192, v193
  v_cvt_pk_bf16_f32 v209, v194, v195
  v_cvt_pk_bf16_f32 v210, v196, v197
  v_cvt_pk_bf16_f32 v211, v198, v199
  v_cvt_pk_bf16_f32 v212, v200, v201
  v_cvt_pk_bf16_f32 v213, v202, v203
  ds_write_b128 v42, v[204:207]
  ds_write_b128 v42, v[208:211] offset:16
  ds_write_b64 v42, v[212:213] offset:32
  v_max3_f32 v44, v240, v241, v242
  v_min3_f32 v45, v240, v241, v242
  v_max3_f32 v44, v44, v243, v244
  v_min3_f32 v45, v45, v243, v244
  v_max3_f32 v44, v44, v245, v246
  v_min3_f32 v45, v45, v245, v246
  v_max3_f32 v44, v44, v247, v248
  v_min3_f32 v45, v45, v247, v248
  v_max3_f32 v44, v44, v249, v250
  v_min3_f32 v45, v45, v249, v250
  v_max3_f32 v44, v44, v251, v252
  v_min3_f32 v45, v45, v251, v252
  v_max3_f32 v44, v44, v253, v254
  v_min3_f32 v45, v45, v253, v254
  v_max3_f32 v44, v44, v255, v80
  v_min3_f32 v45, v45, v255, v80
  v_max_f32 v44, v44, v81
  v_min_f32 v45, v45, v81
  v_pk_mul_f32 v[44:45], v[44:45], v[46:47] op_sel:[0,1] op_sel_hi:[1,0]
  v_pk_fma_f32 v[192:193], v[240:241], v[46:47], v[44:45] op_sel:[0,0,0] op_sel_hi:[0,1,1]
  v_pk_fma_f32 v[194:195], v[240:241], v[46:47], v[44:45] op_sel:[1,0,0] op_sel_hi:[1,1,1]
  v_pk_fma_f32 v[196:197], v[242:243], v[46:47], v[44:45] op_sel:[0,0,0] op_sel_hi:[0,1,1]
  v_exp_f32 v192, v192
  v_exp_f32 v193, v193
  v_pk_fma_f32 v[198:199], v[242:243], v[46:47], v[44:45] op_sel:[1,0,0] op_sel_hi:[1,1,1]
  v_exp_f32 v194, v194
  v_exp_f32 v195, v195
  v_pk_fma_f32 v[200:201], v[244:245], v[46:47], v[44:45] op_sel:[0,0,0] op_sel_hi:[0,1,1]
  v_exp_f32 v196, v196
  v_exp_f32 v197, v197
  v_pk_fma_f32 v[202:203], v[244:245], v[46:47], v[44:45] op_sel:[1,0,0] op_sel_hi:[1,1,1]
  v_exp_f32 v198, v198
  v_exp_f32 v199, v199
  v_pk_fma_f32 v[204:205], v[246:247], v[46:47], v[44:45] op_sel:[0,0,0] op_sel_hi:[0,1,1]
  v_exp_f32 v200, v200
  v_exp_f32 v201, v201
  v_pk_fma_f32 v[206:207], v[246:247], v[46:47], v[44:45] op_sel:[1,0,0] op_sel_hi:[1,1,1]
  v_exp_f32 v202, v202
  v_exp_f32 v203, v203
  v_pk_fma_f32 v[208:209], v[248:249], v[46:47], v[44:45] op_sel:[0,0,0] op_sel_hi:[0,1,1]
  v_exp_f32 v204, v204
  v_exp_f32 v205, v205
  v_pk_fma_f32 v[210:211], v[248:249], v[46:47], v[44:45] op_sel:[1,0,0] op_sel_hi:[1,1,1]
  v_exp_f32 v206, v206
  v_exp_f32 v207, v207
  v_pk_fma_f32 v[212:213], v[250:251], v[46:47], v[44:45] op_sel:[0,0,0] op_sel_hi:[0,1,1]
  v_exp_f32 v208, v208
  v_exp_f32 v209, v209
  v_pk_fma_f32 v[214:215], v[250:251], v[46:47], v[44:45] op_sel:[1,0,0] op_sel_hi:[1,1,1]
  v_exp_f32 v210, v210
  v_exp_f32 v211, v211
  v_pk_fma_f32 v[216:217], v[252:253], v[46:47], v[44:45] op_sel:[0,0,0] op_sel_hi:[0,1,1]
  v_exp_f32 v212, v212
  v_exp_f32 v213, v213
  v_pk_fma_f32 v[218:219], v[252:253], v[46:47], v[44:45] op_sel:[1,0,0] op_sel_hi:[1,1,1]
  v_exp_f32 v214, v214
  v_exp_f32 v215, v215
  v_pk_fma_f32 v[220:221], v[254:255], v[46:47], v[44:45] op_sel:[0,0,0] op_sel_hi:[0,1,1]
  v_exp_f32 v216, v216
  v_exp_f32 v217, v217
  v_pk_fma_f32 v[222:223], v[254:255], v[46:47], v[44:45] op_sel:[1,0,0] op_sel_hi:[1,1,1]
  v_exp_f32 v218, v218
  v_exp_f32 v219, v219
  v_pk_fma_f32 v[224:225], v[80:81], v[46:47], v[44:45] op_sel:[0,0,0] op_sel_hi:[0,1,1]
  v_exp_f32 v220, v220
  v_exp_f32 v221, v221
  v_pk_fma_f32 v[226:227], v[80:81], v[46:47], v[44:45] op_sel:[1,0,0] op_sel_hi:[1,1,1]
  v_exp_f32 v222, v222
  v_exp_f32 v223, v223
  v_exp_f32 v224, v224
  v_exp_f32 v225, v225
  v_exp_f32 v226, v226
  v_exp_f32 v227, v227
  v_pk_add_f32 v[228:229], v[192:193], v[194:195]
  v_pk_add_f32 v[44:45], v[196:197], v[198:199]
  v_pk_add_f32 v[228:229], v[228:229], v[200:201]
  v_pk_add_f32 v[44:45], v[44:45], v[202:203]
  v_pk_add_f32 v[228:229], v[228:229], v[204:205]
  v_pk_add_f32 v[44:45], v[44:45], v[206:207]
  v_pk_add_f32 v[228:229], v[228:229], v[208:209]
  v_pk_add_f32 v[44:45], v[44:45], v[210:211]
  v_pk_add_f32 v[228:229], v[228:229], v[212:213]
  v_pk_add_f32 v[44:45], v[44:45], v[214:215]
  v_pk_add_f32 v[228:229], v[228:229], v[216:217]
  v_pk_add_f32 v[44:45], v[44:45], v[218:219]
  v_pk_add_f32 v[228:229], v[228:229], v[220:221]
  v_pk_add_f32 v[44:45], v[44:45], v[222:223]
  v_pk_add_f32 v[228:229], v[228:229], v[224:225]
  v_pk_add_f32 v[44:45], v[44:45], v[226:227]
  v_pk_add_f32 v[228:229], v[228:229], v[44:45]
  v_rcp_f32 v228, v228
  v_rcp_f32 v229, v229
  s_nop 0
  v_pk_mul_f32 v[192:193], v[192:193], v[228:229]
  v_pk_mul_f32 v[194:195], v[194:195], v[228:229]
  v_pk_mul_f32 v[196:197], v[196:197], v[228:229]
  v_pk_mul_f32 v[198:199], v[198:199], v[228:229]
  v_cvt_pk_bf16_f32 v168, v192, v194
  v_cvt_pk_bf16_f32 v180, v193, v195
  v_pk_mul_f32 v[200:201], v[200:201], v[228:229]
  v_pk_mul_f32 v[202:203], v[202:203], v[228:229]
  v_cvt_pk_bf16_f32 v169, v196, v198
  v_cvt_pk_bf16_f32 v181, v197, v199
  v_pk_mul_f32 v[204:205], v[204:205], v[228:229]
  v_pk_mul_f32 v[206:207], v[206:207], v[228:229]
  v_cvt_pk_bf16_f32 v170, v200, v202
  v_cvt_pk_bf16_f32 v182, v201, v203
  v_pk_mul_f32 v[208:209], v[208:209], v[228:229]
  v_pk_mul_f32 v[210:211], v[210:211], v[228:229]
  v_cvt_pk_bf16_f32 v171, v204, v206
  v_cvt_pk_bf16_f32 v183, v205, v207
  v_pk_mul_f32 v[212:213], v[212:213], v[228:229]
  v_pk_mul_f32 v[214:215], v[214:215], v[228:229]
  v_cvt_pk_bf16_f32 v172, v208, v210
  v_cvt_pk_bf16_f32 v184, v209, v211
  v_pk_mul_f32 v[216:217], v[216:217], v[228:229]
  v_pk_mul_f32 v[218:219], v[218:219], v[228:229]
  v_cvt_pk_bf16_f32 v173, v212, v214
  v_cvt_pk_bf16_f32 v185, v213, v215
  v_pk_mul_f32 v[220:221], v[220:221], v[228:229]
  v_pk_mul_f32 v[222:223], v[222:223], v[228:229]
  v_cvt_pk_bf16_f32 v174, v216, v218
  v_cvt_pk_bf16_f32 v186, v217, v219
  v_pk_mul_f32 v[224:225], v[224:225], v[228:229]
  v_pk_mul_f32 v[226:227], v[226:227], v[228:229]
  v_cvt_pk_bf16_f32 v175, v220, v222
  v_cvt_pk_bf16_f32 v187, v221, v223
  v_cvt_pk_bf16_f32 v176, v224, v226
  v_cvt_pk_bf16_f32 v188, v225, v227
  ds_write_b128 v41, v[168:171]
  ds_write_b128 v41, v[172:175] offset:16
  ds_write_b128 v41, v[180:183] offset:32
  ds_write_b128 v41, v[184:187] offset:48
  v_mov_b32 v177, v188
  ds_write_b64 v41, v[176:177] offset:64
  s_waitcnt lgkmcnt(0)
  s_barrier
  ds_read_b64_tr_b16 v[48:49], v40 offset:0
  ds_read_b64_tr_b16 v[50:51], v40 offset:768
  ds_read_b64_tr_b16 v[52:53], v40 offset:1536
  ds_read_b64_tr_b16 v[54:55], v40 offset:2304
  ds_read_b64_tr_b16 v[56:57], v40 offset:3072
  ds_read_b64_tr_b16 v[58:59], v40 offset:3840
  ds_read_b64_tr_b16 v[60:61], v40 offset:4608
  ds_read_b64_tr_b16 v[62:63], v40 offset:5376
  ds_read_b64_tr_b16 v[192:193], v11 offset:0
  ds_read_b64_tr_b16 v[194:195], v11 offset:1280
  ds_read_b64_tr_b16 v[208:209], v11 offset:32
  ds_read_b64_tr_b16 v[210:211], v11 offset:1312
  ds_read_b64_tr_b16 v[224:225], v11 offset:64
  ds_read_b64_tr_b16 v[226:227], v11 offset:1344
  ds_read_b64_tr_b16 v[196:197], v11 offset:2560
  ds_read_b64_tr_b16 v[198:199], v11 offset:3840
  ds_read_b64_tr_b16 v[212:213], v11 offset:2592
  ds_read_b64_tr_b16 v[214:215], v11 offset:3872
  ds_read_b64_tr_b16 v[228:229], v11 offset:2624
  ds_read_b64_tr_b16 v[230:231], v11 offset:3904
  ds_read_b64_tr_b16 v[200:201], v11 offset:5120
  ds_read_b64_tr_b16 v[202:203], v11 offset:6400
  ds_read_b64_tr_b16 v[216:217], v11 offset:5152
  ds_read_b64_tr_b16 v[218:219], v11 offset:6432
  ds_read_b64_tr_b16 v[232:233], v11 offset:5184
  ds_read_b64_tr_b16 v[234:235], v11 offset:6464
  ds_read_b64_tr_b16 v[204:205], v11 offset:7680
  ds_read_b64_tr_b16 v[206:207], v11 offset:8960
  ds_read_b64_tr_b16 v[220:221], v11 offset:7712
  ds_read_b64_tr_b16 v[222:223], v11 offset:8992
  ds_read_b64_tr_b16 v[236:237], v11 offset:7744
  ds_read_b64_tr_b16 v[238:239], v11 offset:9024
  s_cmp_eq_u32 s3, 0
  s_cbranch_scc0 p1_kernel_pok
  s_lshl_b32 s62, s41, 2
  s_mov_b32 s63, 0
  v_mov_b32 v36, 0
  s_waitcnt vmcnt(0)
  v_readfirstlane_b32 s66, v13
  s_cmp_eq_u32 s66, 1
  s_cbranch_scc1 p1_kernel_pok
p1_kernel_poll:
  buffer_load_dword v32, v36, s[4:7], s62 offen sc0 sc1
  s_waitcnt vmcnt(0)
  v_readfirstlane_b32 s66, v32
  s_cmp_eq_u32 s66, 1
  s_cbranch_scc1 p1_kernel_pok
  s_add_u32 s63, s63, 1
  s_cmp_lt_u32 s63, 0x40000
  s_sleep 1
  s_cbranch_scc1 p1_kernel_poll
p1_kernel_pok:
  s_add_u32 s59, s45, 4096
  s_waitcnt lgkmcnt(15)
  s_waitcnt lgkmcnt(15)
  v_mfma_f32_16x16x32_bf16 v[24:27], v[48:51], v[192:195], 0
  v_mfma_f32_16x16x32_bf16 v[28:31], v[48:51], v[208:211], 0
  v_mfma_f32_16x16x32_bf16 v[32:35], v[48:51], v[224:227], 0
  s_waitcnt lgkmcnt(12)
  v_mfma_f32_16x16x32_bf16 v[24:27], v[52:55], v[196:199], v[24:27]
  v_mfma_f32_16x16x32_bf16 v[28:31], v[52:55], v[212:215], v[28:31]
  v_mfma_f32_16x16x32_bf16 v[32:35], v[52:55], v[228:231], v[32:35]
  s_waitcnt lgkmcnt(6)
  v_mfma_f32_16x16x32_bf16 v[24:27], v[56:59], v[200:203], v[24:27]
  v_mfma_f32_16x16x32_bf16 v[28:31], v[56:59], v[216:219], v[28:31]
  v_mfma_f32_16x16x32_bf16 v[32:35], v[56:59], v[232:235], v[32:35]
  s_waitcnt lgkmcnt(0)
  v_mfma_f32_16x16x32_bf16 v[24:27], v[60:63], v[204:207], v[24:27]
  v_mfma_f32_16x16x32_bf16 v[28:31], v[60:63], v[220:223], v[28:31]
  v_mfma_f32_16x16x32_bf16 v[32:35], v[60:63], v[236:239], v[32:35]
  s_nop 7
  s_mov_b64 exec, s[46:47]
  ds_write_b32 v130, v24 offset:0
  ds_write_b32 v131, v25 offset:0
  ds_write_b32 v132, v26 offset:0
  ds_write_b32 v133, v27 offset:0
  ds_write_b32 v130, v28 offset:384
  ds_write_b32 v131, v29 offset:384
  ds_write_b32 v132, v30 offset:384
  ds_write_b32 v133, v31 offset:384
  s_mov_b64 exec, s[48:49]
  ds_write_b32 v134, v32
  ds_write_b32 v135, v33
  ds_write_b32 v160, v34
  ds_write_b32 v161, v35
  s_mov_b64 exec, -1
  s_waitcnt lgkmcnt(0)
  s_barrier
  ds_read_b32 v24, v162 offset:0
  ds_read_b32 v25, v162 offset:1024
  ds_read_b32 v26, v162 offset:2048
  ds_read_b32 v27, v162 offset:3072
  ds_read_b32 v28, v162 offset:4096
  ds_read_b32 v29, v162 offset:5120
  ds_read_b32 v30, v162 offset:6144
  s_waitcnt lgkmcnt(6)
  buffer_atomic_add_f32 v24, v163, s[20:23], s45 offen offset:0
  s_waitcnt lgkmcnt(5)
  buffer_atomic_add_f32 v25, v163, s[20:23], s45 offen offset:1024
  s_waitcnt lgkmcnt(4)
  buffer_atomic_add_f32 v26, v163, s[20:23], s45 offen offset:2048
  s_waitcnt lgkmcnt(3)
  buffer_atomic_add_f32 v27, v163, s[20:23], s45 offen offset:3072
  s_waitcnt lgkmcnt(2)
  buffer_atomic_add_f32 v28, v163, s[20:23], s59 offen offset:0
  s_waitcnt lgkmcnt(1)
  buffer_atomic_add_f32 v29, v163, s[20:23], s59 offen offset:1024
  s_waitcnt lgkmcnt(0)
  buffer_atomic_add_f32 v30, v12, s[20:23], s59 offen offset:2048
  s_getpc_b64 s[62:63]
p1_kernel_cpf:
  s_add_u32 s62, s62, p2_kernel-p1_kernel_cpf
  s_addc_u32 s63, s63, 0
  v_lshlrev_b32 v20, 7, v1
  v_add_u32 v20, 0, v20
  v_cmp_gt_u32 vcc, ffn_kernel-p2_kernel, v20
  v_mov_b32 v21, 0
  s_nop 0
  v_cndmask_b32 v20, v21, v20, vcc
  global_load_dword v21, v20, s[62:63]
  v_lshlrev_b32 v20, 7, v1
  v_add_u32 v20, 8192, v20
  v_cmp_gt_u32 vcc, ffn_kernel-p2_kernel, v20
  v_mov_b32 v21, 0
  s_nop 0
  v_cndmask_b32 v20, v21, v20, vcc
  global_load_dword v21, v20, s[62:63]
  s_branch p1_kernel_fin
p1_kernel_fin:
p1_kernel_end:
  s_endpgm
.globl p2_kernel
.p2align 8
.type p2_kernel,@function
p2_kernel:
  s_cmp_ge_u32 s2, 256
  s_cbranch_scc1 p2_kernel_end
  s_load_dwordx2 s[4:5], s[0:1], 88
  s_load_dwordx2 s[6:7], s[0:1], 0
  v_and_b32 v1, 63, v0
  v_lshrrev_b32 v9, 6, v0
  s_nop 0
  v_readfirstlane_b32 s40, v9
  s_and_b32 s53, s2, 7
  s_lshr_b32 s54, s2, 3
  s_lshl_b32 s53, s53, 3
  s_lshr_b32 s55, s54, 2
  s_add_u32 s41, s53, s55
  s_and_b32 s42, s54, 3
  v_lshlrev_b32 v2, 4, v1
  v_lshlrev_b32 v3, 2, v1
  v_and_b32 v11, 31, v1
  v_lshrrev_b32 v12, 3, v11
  v_and_b32 v13, 3, v11
  v_lshl_add_u32 v12, v12, 2, v13
  v_cmp_gt_u32 vcc, 12, v12
  v_lshrrev_b32 v14, 2, v11
  v_and_b32 v14, 1, v14
  v_cndmask_b32 v12, v13, v12, vcc
  v_mul_u32_u24 v13, 12, v14
  v_add_u32 v13, v13, v12
  v_lshrrev_b32 v14, 5, v1
  v_mul_u32_u24 v15, 384, v14
  v_lshl_add_u32 v4, v13, 4, v15
  v_mul_u32_u24 v15, 192, v14
  v_lshl_add_u32 v5, v13, 3, v15
  v_add_u32 v5, 3072, v5
  v_lshrrev_b32 v12, 4, v11
  v_mul_u32_u24 v12, 18432, v12
  v_and_b32 v13, 15, v11
  v_lshl_add_u32 v12, v13, 4, v12
  v_mul_u32_u24 v13, 2304, v14
  v_add_u32 v12, v12, v13
  s_mul_i32 s50, s40, 4608
  v_add_u32 v6, s50, v12
  v_and_b32 v12, 15, v1
  v_mul_u32_u24 v12, 1152, v12
  v_lshrrev_b32 v13, 4, v1
  v_lshl_add_u32 v7, v13, 3, v12
  v_mov_b32 v57, 0
  v_mov_b32 v58, 0
  v_mov_b32 v59, 0
  v_mov_b32 v69, 0
  v_mov_b32 v70, 0
  v_mov_b32 v71, 0
  v_accvgpr_write_b32 a153, 0
  v_accvgpr_write_b32 a154, 0
  v_accvgpr_write_b32 a155, 0
  v_accvgpr_write_b32 a165, 0
  v_accvgpr_write_b32 a166, 0
  v_accvgpr_write_b32 a167, 0
  v_accvgpr_write_b32 a177, 0
  v_accvgpr_write_b32 a178, 0
  v_accvgpr_write_b32 a179, 0
  v_accvgpr_write_b32 a189, 0
  v_accvgpr_write_b32 a190, 0
  v_accvgpr_write_b32 a191, 0
  v_accvgpr_write_b32 a201, 0
  v_accvgpr_write_b32 a202, 0
  v_accvgpr_write_b32 a203, 0
  v_accvgpr_write_b32 a213, 0
  v_accvgpr_write_b32 a214, 0
  v_accvgpr_write_b32 a215, 0
  v_accvgpr_write_b32 a225, 0
  v_accvgpr_write_b32 a226, 0
  v_accvgpr_write_b32 a227, 0
  v_accvgpr_write_b32 a237, 0
  v_accvgpr_write_b32 a238, 0
  v_accvgpr_write_b32 a239, 0
  s_waitcnt lgkmcnt(0)
  s_mov_b32 s8, s4
  s_and_b32 s9, s5, 0xffff
  s_mov_b32 s10, 39313408
  s_mov_b32 s11, 0x20000
  s_mov_b32 s12, s6
  s_and_b32 s13, s7, 0xffff
  s_mov_b32 s14, 2359296
  s_mov_b32 s15, 0x20000
  s_lshl_b32 s50, s41, 5
  s_lshl_b32 s51, s40, 3
  s_add_u32 s50, s50, s51
  s_mul_i32 s44, s50, 2304
  s_add_u32 s44, s44, 32514048
  s_mul_i32 s45, s51, 3456
  s_add_u32 s45, s45, 37232640
  buffer_load_dwordx4 a[144:147], v2, s[8:11], s44 offen
  buffer_load_dwordx4 a[148:151], v2, s[8:11], s44 offen offset:1024
  buffer_load_dword a152, v3, s[8:11], s44 offen offset:2048
  buffer_load_dwordx4 v[108:111], v4, s[8:11], s45 offen offset:0
  buffer_load_dwordx4 v[112:115], v4, s[8:11], s45 offen offset:768
  buffer_load_dwordx4 v[116:119], v4, s[8:11], s45 offen offset:1536
  buffer_load_dwordx4 v[120:123], v4, s[8:11], s45 offen offset:2304
  buffer_load_dwordx2 v[124:125], v5, s[8:11], s45 offen
  s_add_u32 s44, s44, 2304
  s_add_u32 s45, s45, 3456
  buffer_load_dwordx4 a[156:159], v2, s[8:11], s44 offen
  buffer_load_dwordx4 a[160:163], v2, s[8:11], s44 offen offset:1024
  buffer_load_dword a164, v3, s[8:11], s44 offen offset:2048
  buffer_load_dwordx4 v[126:129], v4, s[8:11], s45 offen offset:0
  buffer_load_dwordx4 v[130:133], v4, s[8:11], s45 offen offset:768
  buffer_load_dwordx4 v[134:137], v4, s[8:11], s45 offen offset:1536
  buffer_load_dwordx4 v[138:141], v4, s[8:11], s45 offen offset:2304
  buffer_load_dwordx2 v[142:143], v5, s[8:11], s45 offen
  s_add_u32 s44, s44, 2304
  s_add_u32 s45, s45, 3456
  buffer_load_dwordx4 a[168:171], v2, s[8:11], s44 offen
  buffer_load_dwordx4 a[172:175], v2, s[8:11], s44 offen offset:1024
  buffer_load_dword a176, v3, s[8:11], s44 offen offset:2048
  buffer_load_dwordx4 v[144:147], v4, s[8:11], s45 offen offset:0
  buffer_load_dwordx4 v[148:151], v4, s[8:11], s45 offen offset:768
  buffer_load_dwordx4 v[152:155], v4, s[8:11], s45 offen offset:1536
  buffer_load_dwordx4 v[156:159], v4, s[8:11], s45 offen offset:2304
  buffer_load_dwordx2 v[160:161], v5, s[8:11], s45 offen
  s_add_u32 s44, s44, 2304
  s_add_u32 s45, s45, 3456
  buffer_load_dwordx4 a[180:183], v2, s[8:11], s44 offen
  buffer_load_dwordx4 a[184:187], v2, s[8:11], s44 offen offset:1024
  buffer_load_dword a188, v3, s[8:11], s44 offen offset:2048
  buffer_load_dwordx4 v[162:165], v4, s[8:11], s45 offen offset:0
  buffer_load_dwordx4 v[166:169], v4, s[8:11], s45 offen offset:768
  buffer_load_dwordx4 v[170:173], v4, s[8:11], s45 offen offset:1536
  buffer_load_dwordx4 v[174:177], v4, s[8:11], s45 offen offset:2304
  buffer_load_dwordx2 v[178:179], v5, s[8:11], s45 offen
  s_add_u32 s44, s44, 2304
  s_add_u32 s45, s45, 3456
  buffer_load_dwordx4 a[192:195], v2, s[8:11], s44 offen
  buffer_load_dwordx4 a[196:199], v2, s[8:11], s44 offen offset:1024
  buffer_load_dword a200, v3, s[8:11], s44 offen offset:2048
  buffer_load_dwordx4 v[180:183], v4, s[8:11], s45 offen offset:0
  buffer_load_dwordx4 v[184:187], v4, s[8:11], s45 offen offset:768
  buffer_load_dwordx4 v[188:191], v4, s[8:11], s45 offen offset:1536
  buffer_load_dwordx4 v[192:195], v4, s[8:11], s45 offen offset:2304
  buffer_load_dwordx2 v[196:197], v5, s[8:11], s45 offen
  s_add_u32 s44, s44, 2304
  s_add_u32 s45, s45, 3456
  s_mul_i32 s46, s42, 9
  s_add_u32 s46, s46, s40
  s_mul_i32 s47, s46, 18432
  s_add_u32 s47, s47, 10616832
  s_waitcnt vmcnt(32)
  v_cvt_pk_bf16_f32 v48, v108, v109
  v_cvt_pk_bf16_f32 v49, v110, v111
  v_cvt_pk_bf16_f32 v50, v112, v113
  v_cvt_pk_bf16_f32 v51, v114, v115
  v_cvt_pk_bf16_f32 v52, v116, v117
  v_cvt_pk_bf16_f32 v53, v118, v119
  v_cvt_pk_bf16_f32 v54, v120, v121
  v_cvt_pk_bf16_f32 v55, v122, v123
  v_cvt_pk_bf16_f32 v56, v124, v125
  buffer_load_dwordx4 a[204:207], v2, s[8:11], s44 offen
  buffer_load_dwordx4 a[208:211], v2, s[8:11], s44 offen offset:1024
  buffer_load_dword a212, v3, s[8:11], s44 offen offset:2048
  buffer_load_dwordx4 v[198:201], v4, s[8:11], s45 offen offset:0
  buffer_load_dwordx4 v[202:205], v4, s[8:11], s45 offen offset:768
  buffer_load_dwordx4 v[206:209], v4, s[8:11], s45 offen offset:1536
  buffer_load_dwordx4 v[210:213], v4, s[8:11], s45 offen offset:2304
  buffer_load_dwordx2 v[214:215], v5, s[8:11], s45 offen
  s_add_u32 s44, s44, 2304
  s_add_u32 s45, s45, 3456
  v_mfma_f32_32x32x16_bf16 v[16:31], v[48:51], a[144:147], 0
  v_mfma_f32_32x32x16_bf16 v[16:31], v[52:55], a[148:151], v[16:31]
  v_mfma_f32_32x32x16_bf16 v[16:31], v[56:59], a[152:155], v[16:31]
  s_waitcnt vmcnt(32)
  v_cvt_pk_bf16_f32 v60, v126, v127
  v_cvt_pk_bf16_f32 v61, v128, v129
  v_cvt_pk_bf16_f32 v62, v130, v131
  v_cvt_pk_bf16_f32 v63, v132, v133
  v_cvt_pk_bf16_f32 v64, v134, v135
  v_cvt_pk_bf16_f32 v65, v136, v137
  v_cvt_pk_bf16_f32 v66, v138, v139
  v_cvt_pk_bf16_f32 v67, v140, v141
  v_cvt_pk_bf16_f32 v68, v142, v143
  buffer_load_dwordx4 a[216:219], v2, s[8:11], s44 offen
  buffer_load_dwordx4 a[220:223], v2, s[8:11], s44 offen offset:1024
  buffer_load_dword a224, v3, s[8:11], s44 offen offset:2048
  buffer_load_dwordx4 v[216:219], v4, s[8:11], s45 offen offset:0
  buffer_load_dwordx4 v[220:223], v4, s[8:11], s45 offen offset:768
  buffer_load_dwordx4 v[224:227], v4, s[8:11], s45 offen offset:1536
  buffer_load_dwordx4 v[228:231], v4, s[8:11], s45 offen offset:2304
  buffer_load_dwordx2 v[232:233], v5, s[8:11], s45 offen
  s_add_u32 s44, s44, 2304
  s_add_u32 s45, s45, 3456
  v_mfma_f32_32x32x16_bf16 v[32:47], v[60:63], a[156:159], 0
  v_mfma_f32_32x32x16_bf16 v[32:47], v[64:67], a[160:163], v[32:47]
  v_mfma_f32_32x32x16_bf16 v[32:47], v[68:71], a[164:167], v[32:47]
  v_add_f32 v25, 0x358637bd, v25
  v_rcp_f32 v25, v25
  s_nop 0
  v_mul_f32 v16, v16, v25
  v_mul_f32 v17, v17, v25
  v_mul_f32 v18, v18, v25
  v_mul_f32 v19, v19, v25
  v_mul_f32 v20, v20, v25
  v_mul_f32 v21, v21, v25
  v_mul_f32 v22, v22, v25
  v_mul_f32 v23, v23, v25
  v_mul_f32 v24, v24, v25
  v_cvt_pk_bf16_f32 v72, v16, v17
  v_cvt_pk_bf16_f32 v73, v18, v19
  v_cvt_pk_bf16_f32 v74, v20, v21
  v_cvt_pk_bf16_f32 v75, v22, v23
  v_mov_b32 v9, v24
  s_waitcnt vmcnt(32)
  v_cvt_pk_bf16_f32 v48, v144, v145
  v_cvt_pk_bf16_f32 v49, v146, v147
  v_cvt_pk_bf16_f32 v50, v148, v149
  v_cvt_pk_bf16_f32 v51, v150, v151
  v_cvt_pk_bf16_f32 v52, v152, v153
  v_cvt_pk_bf16_f32 v53, v154, v155
  v_cvt_pk_bf16_f32 v54, v156, v157
  v_cvt_pk_bf16_f32 v55, v158, v159
  v_cvt_pk_bf16_f32 v56, v160, v161
  buffer_load_dwordx4 a[228:231], v2, s[8:11], s44 offen
  buffer_load_dwordx4 a[232:235], v2, s[8:11], s44 offen offset:1024
  buffer_load_dword a236, v3, s[8:11], s44 offen offset:2048
  buffer_load_dwordx4 v[234:237], v4, s[8:11], s45 offen offset:0
  buffer_load_dwordx4 v[238:241], v4, s[8:11], s45 offen offset:768
  buffer_load_dwordx4 v[242:245], v4, s[8:11], s45 offen offset:1536
  buffer_load_dwordx4 v[246:249], v4, s[8:11], s45 offen offset:2304
  buffer_load_dwordx2 v[250:251], v5, s[8:11], s45 offen
  s_add_u32 s44, s44, 2304
  s_add_u32 s45, s45, 3456
  v_mfma_f32_32x32x16_bf16 v[16:31], v[48:51], a[168:171], 0
  v_mfma_f32_32x32x16_bf16 v[16:31], v[52:55], a[172:175], v[16:31]
  v_mfma_f32_32x32x16_bf16 v[16:31], v[56:59], a[176:179], v[16:31]
  v_add_f32 v41, 0x358637bd, v41
  v_rcp_f32 v41, v41
  s_nop 0
  v_mul_f32 v32, v32, v41
  v_mul_f32 v33, v33, v41
  v_mul_f32 v34, v34, v41
  v_mul_f32 v35, v35, v41
  v_mul_f32 v36, v36, v41
  v_mul_f32 v37, v37, v41
  v_mul_f32 v38, v38, v41
  v_mul_f32 v39, v39, v41
  v_mul_f32 v40, v40, v41
  v_cvt_pk_bf16_f32 v76, v9, v32
  v_cvt_pk_bf16_f32 v77, v33, v34
  v_cvt_pk_bf16_f32 v78, v35, v36
  v_cvt_pk_bf16_f32 v79, v37, v38
  v_cvt_pk_bf16_f32 v80, v39, v40
  s_waitcnt vmcnt(32)
  v_cvt_pk_bf16_f32 v60, v162, v163
  v_cvt_pk_bf16_f32 v61, v164, v165
  v_cvt_pk_bf16_f32 v62, v166, v167
  v_cvt_pk_bf16_f32 v63, v168, v169
  v_cvt_pk_bf16_f32 v64, v170, v171
  v_cvt_pk_bf16_f32 v65, v172, v173
  v_cvt_pk_bf16_f32 v66, v174, v175
  v_cvt_pk_bf16_f32 v67, v176, v177
  v_cvt_pk_bf16_f32 v68, v178, v179
  s_add_u32 s48, s47, 0
  buffer_load_dwordx4 a[0:3], v2, s[8:11], s48 offen offset:0
  buffer_load_dwordx4 a[4:7], v2, s[8:11], s48 offen offset:1024
  buffer_load_dwordx4 a[8:11], v2, s[8:11], s48 offen offset:2048
  buffer_load_dwordx4 a[12:15], v2, s[8:11], s48 offen offset:3072
  s_add_u32 s48, s47, 4096
  buffer_load_dwordx4 a[16:19], v2, s[8:11], s48 offen offset:0
  buffer_load_dwordx4 a[20:23], v2, s[8:11], s48 offen offset:1024
  v_mfma_f32_32x32x16_bf16 v[32:47], v[60:63], a[180:183], 0
  v_mfma_f32_32x32x16_bf16 v[32:47], v[64:67], a[184:187], v[32:47]
  v_mfma_f32_32x32x16_bf16 v[32:47], v[68:71], a[188:191], v[32:47]
  v_add_f32 v25, 0x358637bd, v25
  v_rcp_f32 v25, v25
  s_nop 0
  v_mul_f32 v16, v16, v25
  v_mul_f32 v17, v17, v25
  v_mul_f32 v18, v18, v25
  v_mul_f32 v19, v19, v25
  v_mul_f32 v20, v20, v25
  v_mul_f32 v21, v21, v25
  v_mul_f32 v22, v22, v25
  v_mul_f32 v23, v23, v25
  v_mul_f32 v24, v24, v25
  v_cvt_pk_bf16_f32 v81, v16, v17
  v_cvt_pk_bf16_f32 v82, v18, v19
  v_cvt_pk_bf16_f32 v83, v20, v21
  v_cvt_pk_bf16_f32 v84, v22, v23
  v_mov_b32 v9, v24
  s_waitcnt vmcnt(30)
  v_cvt_pk_bf16_f32 v48, v180, v181
  v_cvt_pk_bf16_f32 v49, v182, v183
  v_cvt_pk_bf16_f32 v50, v184, v185
  v_cvt_pk_bf16_f32 v51, v186, v187
  v_cvt_pk_bf16_f32 v52, v188, v189
  v_cvt_pk_bf16_f32 v53, v190, v191
  v_cvt_pk_bf16_f32 v54, v192, v193
  v_cvt_pk_bf16_f32 v55, v194, v195
  v_cvt_pk_bf16_f32 v56, v196, v197
  buffer_load_dwordx4 a[24:27], v2, s[8:11], s48 offen offset:2048
  buffer_load_dwordx4 a[28:31], v2, s[8:11], s48 offen offset:3072
  s_add_u32 s48, s47, 8192
  buffer_load_dwordx4 a[32:35], v2, s[8:11], s48 offen offset:0
  buffer_load_dwordx4 a[36:39], v2, s[8:11], s48 offen offset:1024
  buffer_load_dwordx4 a[40:43], v2, s[8:11], s48 offen offset:2048
  buffer_load_dwordx4 a[44:47], v2, s[8:11], s48 offen offset:3072
  v_mfma_f32_32x32x16_bf16 v[16:31], v[48:51], a[192:195], 0
  v_mfma_f32_32x32x16_bf16 v[16:31], v[52:55], a[196:199], v[16:31]
  v_mfma_f32_32x32x16_bf16 v[16:31], v[56:59], a[200:203], v[16:31]
  v_add_f32 v41, 0x358637bd, v41
  v_rcp_f32 v41, v41
  s_nop 0
  v_mul_f32 v32, v32, v41
  v_mul_f32 v33, v33, v41
  v_mul_f32 v34, v34, v41
  v_mul_f32 v35, v35, v41
  v_mul_f32 v36, v36, v41
  v_mul_f32 v37, v37, v41
  v_mul_f32 v38, v38, v41
  v_mul_f32 v39, v39, v41
  v_mul_f32 v40, v40, v41
  v_cvt_pk_bf16_f32 v85, v9, v32
  v_cvt_pk_bf16_f32 v86, v33, v34
  v_cvt_pk_bf16_f32 v87, v35, v36
  v_cvt_pk_bf16_f32 v88, v37, v38
  v_cvt_pk_bf16_f32 v89, v39, v40
  s_waitcnt vmcnt(28)
  v_cvt_pk_bf16_f32 v60, v198, v199
  v_cvt_pk_bf16_f32 v61, v200, v201
  v_cvt_pk_bf16_f32 v62, v202, v203
  v_cvt_pk_bf16_f32 v63, v204, v205
  v_cvt_pk_bf16_f32 v64, v206, v207
  v_cvt_pk_bf16_f32 v65, v208, v209
  v_cvt_pk_bf16_f32 v66, v210, v211
  v_cvt_pk_bf16_f32 v67, v212, v213
  v_cvt_pk_bf16_f32 v68, v214, v215
  s_add_u32 s48, s47, 12288
  buffer_load_dwordx4 a[48:51], v2, s[8:11], s48 offen offset:0
  buffer_load_dwordx4 a[52:55], v2, s[8:11], s48 offen offset:1024
  buffer_load_dwordx4 a[56:59], v2, s[8:11], s48 offen offset:2048
  buffer_load_dwordx4 a[60:63], v2, s[8:11], s48 offen offset:3072
  s_add_u32 s48, s47, 16384
  buffer_load_dwordx4 a[64:67], v2, s[8:11], s48 offen offset:0
  buffer_load_dwordx4 a[68:71], v2, s[8:11], s48 offen offset:1024
  v_mfma_f32_32x32x16_bf16 v[32:47], v[60:63], a[204:207], 0
  v_mfma_f32_32x32x16_bf16 v[32:47], v[64:67], a[208:211], v[32:47]
  v_mfma_f32_32x32x16_bf16 v[32:47], v[68:71], a[212:215], v[32:47]
  v_add_f32 v25, 0x358637bd, v25
  v_rcp_f32 v25, v25
  s_nop 0
  v_mul_f32 v16, v16, v25
  v_mul_f32 v17, v17, v25
  v_mul_f32 v18, v18, v25
  v_mul_f32 v19, v19, v25
  v_mul_f32 v20, v20, v25
  v_mul_f32 v21, v21, v25
  v_mul_f32 v22, v22, v25
  v_mul_f32 v23, v23, v25
  v_mul_f32 v24, v24, v25
  v_cvt_pk_bf16_f32 v90, v16, v17
  v_cvt_pk_bf16_f32 v91, v18, v19
  v_cvt_pk_bf16_f32 v92, v20, v21
  v_cvt_pk_bf16_f32 v93, v22, v23
  v_mov_b32 v9, v24
  s_waitcnt vmcnt(26)
  v_cvt_pk_bf16_f32 v48, v216, v217
  v_cvt_pk_bf16_f32 v49, v218, v219
  v_cvt_pk_bf16_f32 v50, v220, v221
  v_cvt_pk_bf16_f32 v51, v222, v223
  v_cvt_pk_bf16_f32 v52, v224, v225
  v_cvt_pk_bf16_f32 v53, v226, v227
  v_cvt_pk_bf16_f32 v54, v228, v229
  v_cvt_pk_bf16_f32 v55, v230, v231
  v_cvt_pk_bf16_f32 v56, v232, v233
  s_add_u32 s48, s47, 73728
  buffer_load_dwordx4 a[72:75], v2, s[8:11], s48 offen offset:0
  buffer_load_dwordx4 a[76:79], v2, s[8:11], s48 offen offset:1024
  buffer_load_dwordx4 a[80:83], v2, s[8:11], s48 offen offset:2048
  buffer_load_dwordx4 a[84:87], v2, s[8:11], s48 offen offset:3072
  s_add_u32 s48, s47, 77824
  buffer_load_dwordx4 a[88:91], v2, s[8:11], s48 offen offset:0
  buffer_load_dwordx4 a[92:95], v2, s[8:11], s48 offen offset:1024
  v_mfma_f32_32x32x16_bf16 v[16:31], v[48:51], a[216:219], 0
  v_mfma_f32_32x32x16_bf16 v[16:31], v[52:55], a[220:223], v[16:31]
  v_mfma_f32_32x32x16_bf16 v[16:31], v[56:59], a[224:227], v[16:31]
  v_add_f32 v41, 0x358637bd, v41
  v_rcp_f32 v41, v41
  s_nop 0
  v_mul_f32 v32, v32, v41
  v_mul_f32 v33, v33, v41
  v_mul_f32 v34, v34, v41
  v_mul_f32 v35, v35, v41
  v_mul_f32 v36, v36, v41
  v_mul_f32 v37, v37, v41
  v_mul_f32 v38, v38, v41
  v_mul_f32 v39, v39, v41
  v_mul_f32 v40, v40, v41
  v_cvt_pk_bf16_f32 v94, v9, v32
  v_cvt_pk_bf16_f32 v95, v33, v34
  v_cvt_pk_bf16_f32 v96, v35, v36
  v_cvt_pk_bf16_f32 v97, v37, v38
  v_cvt_pk_bf16_f32 v98, v39, v40
  s_waitcnt vmcnt(24)
  v_cvt_pk_bf16_f32 v60, v234, v235
  v_cvt_pk_bf16_f32 v61, v236, v237
  v_cvt_pk_bf16_f32 v62, v238, v239
  v_cvt_pk_bf16_f32 v63, v240, v241
  v_cvt_pk_bf16_f32 v64, v242, v243
  v_cvt_pk_bf16_f32 v65, v244, v245
  v_cvt_pk_bf16_f32 v66, v246, v247
  v_cvt_pk_bf16_f32 v67, v248, v249
  v_cvt_pk_bf16_f32 v68, v250, v251
  buffer_load_dwordx4 a[96:99], v2, s[8:11], s48 offen offset:2048
  buffer_load_dwordx4 a[100:103], v2, s[8:11], s48 offen offset:3072
  s_add_u32 s48, s47, 81920
  buffer_load_dwordx4 a[104:107], v2, s[8:11], s48 offen offset:0
  buffer_load_dwordx4 a[108:111], v2, s[8:11], s48 offen offset:1024
  buffer_load_dwordx4 a[112:115], v2, s[8:11], s48 offen offset:2048
  buffer_load_dwordx4 a[116:119], v2, s[8:11], s48 offen offset:3072
  v_mfma_f32_32x32x16_bf16 v[32:47], v[60:63], a[228:231], 0
  v_mfma_f32_32x32x16_bf16 v[32:47], v[64:67], a[232:235], v[32:47]
  v_mfma_f32_32x32x16_bf16 v[32:47], v[68:71], a[236:239], v[32:47]
  v_add_f32 v25, 0x358637bd, v25
  v_rcp_f32 v25, v25
  s_nop 0
  v_mul_f32 v16, v16, v25
  v_mul_f32 v17, v17, v25
  v_mul_f32 v18, v18, v25
  v_mul_f32 v19, v19, v25
  v_mul_f32 v20, v20, v25
  v_mul_f32 v21, v21, v25
  v_mul_f32 v22, v22, v25
  v_mul_f32 v23, v23, v25
  v_mul_f32 v24, v24, v25
  v_cvt_pk_bf16_f32 v99, v16, v17
  v_cvt_pk_bf16_f32 v100, v18, v19
  v_cvt_pk_bf16_f32 v101, v20, v21
  v_cvt_pk_bf16_f32 v102, v22, v23
  v_mov_b32 v9, v24
  s_add_u32 s48, s47, 86016
  buffer_load_dwordx4 a[120:123], v2, s[8:11], s48 offen offset:0
  buffer_load_dwordx4 a[124:127], v2, s[8:11], s48 offen offset:1024
  buffer_load_dwordx4 a[128:131], v2, s[8:11], s48 offen offset:2048
  buffer_load_dwordx4 a[132:135], v2, s[8:11], s48 offen offset:3072
  s_add_u32 s48, s47, 90112
  buffer_load_dwordx4 a[136:139], v2, s[8:11], s48 offen offset:0
  buffer_load_dwordx4 a[140:143], v2, s[8:11], s48 offen offset:1024
  s_nop 7
  v_add_f32 v41, 0x358637bd, v41
  v_rcp_f32 v41, v41
  s_nop 0
  v_mul_f32 v32, v32, v41
  v_mul_f32 v33, v33, v41
  v_mul_f32 v34, v34, v41
  v_mul_f32 v35, v35, v41
  v_mul_f32 v36, v36, v41
  v_mul_f32 v37, v37, v41
  v_mul_f32 v38, v38, v41
  v_mul_f32 v39, v39, v41
  v_mul_f32 v40, v40, v41
  v_cvt_pk_bf16_f32 v103, v9, v32
  v_cvt_pk_bf16_f32 v104, v33, v34
  v_cvt_pk_bf16_f32 v105, v35, v36
  v_cvt_pk_bf16_f32 v106, v37, v38
  v_cvt_pk_bf16_f32 v107, v39, v40
  ds_write_b128 v6, v[72:75] offset:0
  ds_write_b128 v6, v[76:79] offset:256
  ds_write_b128 v6, v[80:83] offset:512
  ds_write_b128 v6, v[84:87] offset:768
  ds_write_b128 v6, v[88:91] offset:1024
  ds_write_b128 v6, v[92:95] offset:1280
  ds_write_b128 v6, v[96:99] offset:1536
  ds_write_b128 v6, v[100:103] offset:1792
  ds_write_b128 v6, v[104:107] offset:2048
  s_mul_i32 s49, s41, 36864
  s_lshl_b32 s50, s46, 5
  s_add_u32 s49, s49, s50
  s_add_u32 s50, s49, 0
  buffer_load_dwordx2 v[16:17], v7, s[12:15], s50 offen
  s_add_u32 s50, s49, 18432
  buffer_load_dwordx2 v[18:19], v7, s[12:15], s50 offen
  s_add_u32 s50, s49, 128
  buffer_load_dwordx2 v[20:21], v7, s[12:15], s50 offen
  s_add_u32 s50, s49, 18560
  buffer_load_dwordx2 v[22:23], v7, s[12:15], s50 offen
  s_waitcnt lgkmcnt(0)
  s_barrier
  ds_read_b128 v[108:111], v2 offset:0
  ds_read_b128 v[180:183], v2 offset:18432
  ds_read_b128 v[112:115], v2 offset:1024
  ds_read_b128 v[184:187], v2 offset:19456
  ds_read_b128 v[116:119], v2 offset:2048
  ds_read_b128 v[188:191], v2 offset:20480
  ds_read_b128 v[120:123], v2 offset:3072
  ds_read_b128 v[192:195], v2 offset:21504
  ds_read_b128 v[124:127], v2 offset:4096
  ds_read_b128 v[196:199], v2 offset:22528
  ds_read_b128 v[128:131], v2 offset:5120
  ds_read_b128 v[200:203], v2 offset:23552
  ds_read_b128 v[132:135], v2 offset:6144
  ds_read_b128 v[204:207], v2 offset:24576
  ds_read_b128 v[136:139], v2 offset:7168
  ds_read_b128 v[208:211], v2 offset:25600
  ds_read_b128 v[140:143], v2 offset:8192
  ds_read_b128 v[212:215], v2 offset:26624
  ds_read_b128 v[144:147], v2 offset:9216
  ds_read_b128 v[216:219], v2 offset:27648
  ds_read_b128 v[148:151], v2 offset:10240
  ds_read_b128 v[220:223], v2 offset:28672
  ds_read_b128 v[152:155], v2 offset:11264
  ds_read_b128 v[224:227], v2 offset:29696
  ds_read_b128 v[156:159], v2 offset:12288
  ds_read_b128 v[228:231], v2 offset:30720
  ds_read_b128 v[160:163], v2 offset:13312
  ds_read_b128 v[232:235], v2 offset:31744
  ds_read_b128 v[164:167], v2 offset:14336
  ds_read_b128 v[236:239], v2 offset:32768
  ds_read_b128 v[168:171], v2 offset:15360
  ds_read_b128 v[240:243], v2 offset:33792
  ds_read_b128 v[172:175], v2 offset:16384
  ds_read_b128 v[244:247], v2 offset:34816
  ds_read_b128 v[176:179], v2 offset:17408
  ds_read_b128 v[248:251], v2 offset:35840
  s_cmp_lg_u32 s40, 0
  s_cbranch_scc1 p2_kernel_no3a
  s_add_u32 s48, s47, 147456
  buffer_load_dwordx4 a[144:147], v2, s[8:11], s48 offen offset:0
  buffer_load_dwordx4 a[148:151], v2, s[8:11], s48 offen offset:1024
  buffer_load_dwordx4 a[152:155], v2, s[8:11], s48 offen offset:2048
  buffer_load_dwordx4 a[156:159], v2, s[8:11], s48 offen offset:3072
  s_add_u32 s48, s47, 151552
  buffer_load_dwordx4 a[160:163], v2, s[8:11], s48 offen offset:0
  buffer_load_dwordx4 a[164:167], v2, s[8:11], s48 offen offset:1024
  buffer_load_dwordx4 a[168:171], v2, s[8:11], s48 offen offset:2048
  buffer_load_dwordx4 a[172:175], v2, s[8:11], s48 offen offset:3072
  s_add_u32 s48, s47, 155648
  buffer_load_dwordx4 a[176:179], v2, s[8:11], s48 offen offset:0
  buffer_load_dwordx4 a[180:183], v2, s[8:11], s48 offen offset:1024
  buffer_load_dwordx4 a[184:187], v2, s[8:11], s48 offen offset:2048
  buffer_load_dwordx4 a[188:191], v2, s[8:11], s48 offen offset:3072
  s_add_u32 s48, s47, 159744
  buffer_load_dwordx4 a[192:195], v2, s[8:11], s48 offen offset:0
  buffer_load_dwordx4 a[196:199], v2, s[8:11], s48 offen offset:1024
  buffer_load_dwordx4 a[200:203], v2, s[8:11], s48 offen offset:2048
  buffer_load_dwordx4 a[204:207], v2, s[8:11], s48 offen offset:3072
  s_add_u32 s48, s47, 163840
  buffer_load_dwordx4 a[208:211], v2, s[8:11], s48 offen offset:0
  buffer_load_dwordx4 a[212:215], v2, s[8:11], s48 offen offset:1024
  s_add_u32 s50, s49, 256
  buffer_load_dwordx2 v[24:25], v7, s[12:15], s50 offen
  s_add_u32 s50, s49, 18688
  buffer_load_dwordx2 v[26:27], v7, s[12:15], s50 offen
p2_kernel_no3a:
  s_waitcnt lgkmcnt(0)
  s_mov_b32 s60, 0x3f803f80
  v_mov_b32 v252, 0
  v_mov_b32 v253, 0
  v_mov_b32 v254, 0
  v_mov_b32 v255, 0
  s_cmp_lg_u32 s40, 0
  s_cbranch_scc1 p2_kernel_no3t
  s_waitcnt vmcnt(57)
  v_mfma_f32_16x16x32_bf16 v[32:35], a[0:3], v[108:111], 0
  v_mfma_f32_16x16x32_bf16 v[36:39], a[0:3], v[180:183], 0
  v_mfma_f32_16x16x32_bf16 v[32:35], a[4:7], v[112:115], v[32:35]
  v_mfma_f32_16x16x32_bf16 v[36:39], a[4:7], v[184:187], v[36:39]
  v_mfma_f32_16x16x32_bf16 v[32:35], a[8:11], v[116:119], v[32:35]
  v_mfma_f32_16x16x32_bf16 v[36:39], a[8:11], v[188:191], v[36:39]
  s_waitcnt vmcnt(54)
  v_mfma_f32_16x16x32_bf16 v[32:35], a[12:15], v[120:123], v[32:35]
  v_mfma_f32_16x16x32_bf16 v[36:39], a[12:15], v[192:195], v[36:39]
  v_mfma_f32_16x16x32_bf16 v[32:35], a[16:19], v[124:127], v[32:35]
  v_mfma_f32_16x16x32_bf16 v[36:39], a[16:19], v[196:199], v[36:39]
  v_mfma_f32_16x16x32_bf16 v[32:35], a[20:23], v[128:131], v[32:35]
  v_mfma_f32_16x16x32_bf16 v[36:39], a[20:23], v[200:203], v[36:39]
  s_waitcnt vmcnt(51)
  v_mfma_f32_16x16x32_bf16 v[32:35], a[24:27], v[132:135], v[32:35]
  v_mfma_f32_16x16x32_bf16 v[36:39], a[24:27], v[204:207], v[36:39]
  v_mfma_f32_16x16x32_bf16 v[32:35], a[28:31], v[136:139], v[32:35]
  v_mfma_f32_16x16x32_bf16 v[36:39], a[28:31], v[208:211], v[36:39]
  v_mfma_f32_16x16x32_bf16 v[32:35], a[32:35], v[140:143], v[32:35]
  v_mfma_f32_16x16x32_bf16 v[36:39], a[32:35], v[212:215], v[36:39]
  s_waitcnt vmcnt(48)
  v_mfma_f32_16x16x32_bf16 v[32:35], a[36:39], v[144:147], v[32:35]
  v_mfma_f32_16x16x32_bf16 v[36:39], a[36:39], v[216:219], v[36:39]
  v_mfma_f32_16x16x32_bf16 v[32:35], a[40:43], v[148:151], v[32:35]
  v_mfma_f32_16x16x32_bf16 v[36:39], a[40:43], v[220:223], v[36:39]
  v_mfma_f32_16x16x32_bf16 v[32:35], a[44:47], v[152:155], v[32:35]
  v_mfma_f32_16x16x32_bf16 v[36:39], a[44:47], v[224:227], v[36:39]
  s_waitcnt vmcnt(45)
  v_mfma_f32_16x16x32_bf16 v[32:35], a[48:51], v[156:159], v[32:35]
  v_mfma_f32_16x16x32_bf16 v[36:39], a[48:51], v[228:231], v[36:39]
  v_mfma_f32_16x16x32_bf16 v[32:35], a[52:55], v[160:163], v[32:35]
  v_mfma_f32_16x16x32_bf16 v[36:39], a[52:55], v[232:235], v[36:39]
  v_mfma_f32_16x16x32_bf16 v[32:35], a[56:59], v[164:167], v[32:35]
  v_mfma_f32_16x16x32_bf16 v[36:39], a[56:59], v[236:239], v[36:39]
  s_waitcnt vmcnt(42)
  v_mfma_f32_16x16x32_bf16 v[32:35], a[60:63], v[168:171], v[32:35]
  v_mfma_f32_16x16x32_bf16 v[36:39], a[60:63], v[240:243], v[36:39]
  v_mfma_f32_16x16x32_bf16 v[32:35], a[64:67], v[172:175], v[32:35]
  v_mfma_f32_16x16x32_bf16 v[36:39], a[64:67], v[244:247], v[36:39]
  v_mfma_f32_16x16x32_bf16 v[32:35], a[68:71], v[176:179], v[32:35]
  v_mfma_f32_16x16x32_bf16 v[36:39], a[68:71], v[248:251], v[36:39]
  s_waitcnt vmcnt(39)
  v_mfma_f32_16x16x32_bf16 v[40:43], a[72:75], v[108:111], 0
  v_mfma_f32_16x16x32_bf16 v[44:47], a[72:75], v[180:183], 0
  v_mfma_f32_16x16x32_bf16 v[40:43], a[76:79], v[112:115], v[40:43]
  v_mfma_f32_16x16x32_bf16 v[44:47], a[76:79], v[184:187], v[44:47]
  v_mfma_f32_16x16x32_bf16 v[40:43], a[80:83], v[116:119], v[40:43]
  v_mfma_f32_16x16x32_bf16 v[44:47], a[80:83], v[188:191], v[44:47]
  s_waitcnt vmcnt(36)
  v_mfma_f32_16x16x32_bf16 v[40:43], a[84:87], v[120:123], v[40:43]
  v_mfma_f32_16x16x32_bf16 v[44:47], a[84:87], v[192:195], v[44:47]
  v_mfma_f32_16x16x32_bf16 v[40:43], a[88:91], v[124:127], v[40:43]
  v_mfma_f32_16x16x32_bf16 v[44:47], a[88:91], v[196:199], v[44:47]
  v_mfma_f32_16x16x32_bf16 v[40:43], a[92:95], v[128:131], v[40:43]
  v_mfma_f32_16x16x32_bf16 v[44:47], a[92:95], v[200:203], v[44:47]
  s_waitcnt vmcnt(33)
  v_mfma_f32_16x16x32_bf16 v[40:43], a[96:99], v[132:135], v[40:43]
  v_mfma_f32_16x16x32_bf16 v[44:47], a[96:99], v[204:207], v[44:47]
  v_mfma_f32_16x16x32_bf16 v[40:43], a[100:103], v[136:139], v[40:43]
  v_mfma_f32_16x16x32_bf16 v[44:47], a[100:103], v[208:211], v[44:47]
  v_mfma_f32_16x16x32_bf16 v[40:43], a[104:107], v[140:143], v[40:43]
  v_mfma_f32_16x16x32_bf16 v[44:47], a[104:107], v[212:215], v[44:47]
  s_waitcnt vmcnt(30)
  v_mfma_f32_16x16x32_bf16 v[40:43], a[108:111], v[144:147], v[40:43]
  v_mfma_f32_16x16x32_bf16 v[44:47], a[108:111], v[216:219], v[44:47]
  v_mfma_f32_16x16x32_bf16 v[40:43], a[112:115], v[148:151], v[40:43]
  v_mfma_f32_16x16x32_bf16 v[44:47], a[112:115], v[220:223], v[44:47]
  v_mfma_f32_16x16x32_bf16 v[40:43], a[116:119], v[152:155], v[40:43]
  v_mfma_f32_16x16x32_bf16 v[44:47], a[116:119], v[224:227], v[44:47]
  s_waitcnt vmcnt(27)
  v_mfma_f32_16x16x32_bf16 v[40:43], a[120:123], v[156:159], v[40:43]
  v_mfma_f32_16x16x32_bf16 v[44:47], a[120:123], v[228:231], v[44:47]
  v_mfma_f32_16x16x32_bf16 v[40:43], a[124:127], v[160:163], v[40:43]
  v_mfma_f32_16x16x32_bf16 v[44:47], a[124:127], v[232:235], v[44:47]
  v_mfma_f32_16x16x32_bf16 v[40:43], a[128:131], v[164:167], v[40:43]
  v_mfma_f32_16x16x32_bf16 v[44:47], a[128:131], v[236:239], v[44:47]
  s_waitcnt vmcnt(24)
  v_mfma_f32_16x16x32_bf16 v[40:43], a[132:135], v[168:171], v[40:43]
  v_mfma_f32_16x16x32_bf16 v[44:47], a[132:135], v[240:243], v[44:47]
  v_mfma_f32_16x16x32_bf16 v[40:43], a[136:139], v[172:175], v[40:43]
  v_mfma_f32_16x16x32_bf16 v[44:47], a[136:139], v[244:247], v[44:47]
  v_mfma_f32_16x16x32_bf16 v[40:43], a[140:143], v[176:179], v[40:43]
  v_mfma_f32_16x16x32_bf16 v[44:47], a[140:143], v[248:251], v[44:47]
  s_waitcnt vmcnt(0)
  s_add_u32 s50, s46, 0
  s_lshr_b32 s51, s50, 1
  s_and_b32 s52, s50, 1
  s_lshl_b32 s52, s52, 3
  v_lshlrev_b32 v72, 16, v16
  v_and_b32 v73, 0xffff0000, v16
  v_lshlrev_b32 v74, 16, v17
  v_and_b32 v75, 0xffff0000, v17
  v_add_f32 v72, v72, v32
  v_add_f32 v73, v73, v33
  v_add_f32 v74, v74, v34
  v_add_f32 v75, v75, v35
  v_cvt_pk_bf16_f32 v76, v72, v73
  v_cvt_pk_bf16_f32 v77, v74, v75
  v_dot2c_f32_bf16 v252, s60, v76
  v_dot2c_f32_bf16 v253, v76, v76
  v_dot2c_f32_bf16 v252, s60, v77
  v_dot2c_f32_bf16 v253, v77, v77
  s_lshl_b32 s55, s41, 1
  s_add_u32 s55, s55, 0
  s_mul_i32 s55, s55, 18
  s_add_u32 s55, s55, s51
  s_lshl_b32 s55, s55, 10
  s_add_u32 s55, s55, s52
  s_add_u32 s55, s55, 11280384
  buffer_store_dwordx2 v[76:77], v2, s[8:11], s55 offen
  v_lshlrev_b32 v72, 16, v18
  v_and_b32 v73, 0xffff0000, v18
  v_lshlrev_b32 v74, 16, v19
  v_and_b32 v75, 0xffff0000, v19
  v_add_f32 v72, v72, v36
  v_add_f32 v73, v73, v37
  v_add_f32 v74, v74, v38
  v_add_f32 v75, v75, v39
  v_cvt_pk_bf16_f32 v78, v72, v73
  v_cvt_pk_bf16_f32 v79, v74, v75
  v_dot2c_f32_bf16 v254, s60, v78
  v_dot2c_f32_bf16 v255, v78, v78
  v_dot2c_f32_bf16 v254, s60, v79
  v_dot2c_f32_bf16 v255, v79, v79
  s_lshl_b32 s55, s41, 1
  s_add_u32 s55, s55, 1
  s_mul_i32 s55, s55, 18
  s_add_u32 s55, s55, s51
  s_lshl_b32 s55, s55, 10
  s_add_u32 s55, s55, s52
  s_add_u32 s55, s55, 11280384
  buffer_store_dwordx2 v[78:79], v2, s[8:11], s55 offen
  v_mfma_f32_16x16x32_bf16 v[32:35], a[144:147], v[108:111], 0
  v_mfma_f32_16x16x32_bf16 v[36:39], a[144:147], v[180:183], 0
  v_mfma_f32_16x16x32_bf16 v[32:35], a[148:151], v[112:115], v[32:35]
  v_mfma_f32_16x16x32_bf16 v[36:39], a[148:151], v[184:187], v[36:39]
  v_mfma_f32_16x16x32_bf16 v[32:35], a[152:155], v[116:119], v[32:35]
  v_mfma_f32_16x16x32_bf16 v[36:39], a[152:155], v[188:191], v[36:39]
  v_mfma_f32_16x16x32_bf16 v[32:35], a[156:159], v[120:123], v[32:35]
  v_mfma_f32_16x16x32_bf16 v[36:39], a[156:159], v[192:195], v[36:39]
  v_mfma_f32_16x16x32_bf16 v[32:35], a[160:163], v[124:127], v[32:35]
  v_mfma_f32_16x16x32_bf16 v[36:39], a[160:163], v[196:199], v[36:39]
  v_mfma_f32_16x16x32_bf16 v[32:35], a[164:167], v[128:131], v[32:35]
  v_mfma_f32_16x16x32_bf16 v[36:39], a[164:167], v[200:203], v[36:39]
  v_mfma_f32_16x16x32_bf16 v[32:35], a[168:171], v[132:135], v[32:35]
  v_mfma_f32_16x16x32_bf16 v[36:39], a[168:171], v[204:207], v[36:39]
  v_mfma_f32_16x16x32_bf16 v[32:35], a[172:175], v[136:139], v[32:35]
  v_mfma_f32_16x16x32_bf16 v[36:39], a[172:175], v[208:211], v[36:39]
  v_mfma_f32_16x16x32_bf16 v[32:35], a[176:179], v[140:143], v[32:35]
  v_mfma_f32_16x16x32_bf16 v[36:39], a[176:179], v[212:215], v[36:39]
  v_mfma_f32_16x16x32_bf16 v[32:35], a[180:183], v[144:147], v[32:35]
  v_mfma_f32_16x16x32_bf16 v[36:39], a[180:183], v[216:219], v[36:39]
  v_mfma_f32_16x16x32_bf16 v[32:35], a[184:187], v[148:151], v[32:35]
  v_mfma_f32_16x16x32_bf16 v[36:39], a[184:187], v[220:223], v[36:39]
  v_mfma_f32_16x16x32_bf16 v[32:35], a[188:191], v[152:155], v[32:35]
  v_mfma_f32_16x16x32_bf16 v[36:39], a[188:191], v[224:227], v[36:39]
  v_mfma_f32_16x16x32_bf16 v[32:35], a[192:195], v[156:159], v[32:35]
  v_mfma_f32_16x16x32_bf16 v[36:39], a[192:195], v[228:231], v[36:39]
  v_mfma_f32_16x16x32_bf16 v[32:35], a[196:199], v[160:163], v[32:35]
  v_mfma_f32_16x16x32_bf16 v[36:39], a[196:199], v[232:235], v[36:39]
  v_mfma_f32_16x16x32_bf16 v[32:35], a[200:203], v[164:167], v[32:35]
  v_mfma_f32_16x16x32_bf16 v[36:39], a[200:203], v[236:239], v[36:39]
  v_mfma_f32_16x16x32_bf16 v[32:35], a[204:207], v[168:171], v[32:35]
  v_mfma_f32_16x16x32_bf16 v[36:39], a[204:207], v[240:243], v[36:39]
  v_mfma_f32_16x16x32_bf16 v[32:35], a[208:211], v[172:175], v[32:35]
  v_mfma_f32_16x16x32_bf16 v[36:39], a[208:211], v[244:247], v[36:39]
  v_mfma_f32_16x16x32_bf16 v[32:35], a[212:215], v[176:179], v[32:35]
  v_mfma_f32_16x16x32_bf16 v[36:39], a[212:215], v[248:251], v[36:39]
  s_add_u32 s50, s46, 4
  s_lshr_b32 s51, s50, 1
  s_and_b32 s52, s50, 1
  s_lshl_b32 s52, s52, 3
  v_lshlrev_b32 v72, 16, v20
  v_and_b32 v73, 0xffff0000, v20
  v_lshlrev_b32 v74, 16, v21
  v_and_b32 v75, 0xffff0000, v21
  v_add_f32 v72, v72, v40
  v_add_f32 v73, v73, v41
  v_add_f32 v74, v74, v42
  v_add_f32 v75, v75, v43
  v_cvt_pk_bf16_f32 v76, v72, v73
  v_cvt_pk_bf16_f32 v77, v74, v75
  v_dot2c_f32_bf16 v252, s60, v76
  v_dot2c_f32_bf16 v253, v76, v76
  v_dot2c_f32_bf16 v252, s60, v77
  v_dot2c_f32_bf16 v253, v77, v77
  s_lshl_b32 s55, s41, 1
  s_add_u32 s55, s55, 0
  s_mul_i32 s55, s55, 18
  s_add_u32 s55, s55, s51
  s_lshl_b32 s55, s55, 10
  s_add_u32 s55, s55, s52
  s_add_u32 s55, s55, 11280384
  buffer_store_dwordx2 v[76:77], v2, s[8:11], s55 offen
  v_lshlrev_b32 v72, 16, v22
  v_and_b32 v73, 0xffff0000, v22
  v_lshlrev_b32 v74, 16, v23
  v_and_b32 v75, 0xffff0000, v23
  v_add_f32 v72, v72, v44
  v_add_f32 v73, v73, v45
  v_add_f32 v74, v74, v46
  v_add_f32 v75, v75, v47
  v_cvt_pk_bf16_f32 v78, v72, v73
  v_cvt_pk_bf16_f32 v79, v74, v75
  v_dot2c_f32_bf16 v254, s60, v78
  v_dot2c_f32_bf16 v255, v78, v78
  v_dot2c_f32_bf16 v254, s60, v79
  v_dot2c_f32_bf16 v255, v79, v79
  s_lshl_b32 s55, s41, 1
  s_add_u32 s55, s55, 1
  s_mul_i32 s55, s55, 18
  s_add_u32 s55, s55, s51
  s_lshl_b32 s55, s55, 10
  s_add_u32 s55, s55, s52
  s_add_u32 s55, s55, 11280384
  buffer_store_dwordx2 v[78:79], v2, s[8:11], s55 offen
  s_nop 7
  s_add_u32 s50, s46, 8
  s_lshr_b32 s51, s50, 1
  s_and_b32 s52, s50, 1
  s_lshl_b32 s52, s52, 3
  v_lshlrev_b32 v72, 16, v24
  v_and_b32 v73, 0xffff0000, v24
  v_lshlrev_b32 v74, 16, v25
  v_and_b32 v75, 0xffff0000, v25
  v_add_f32 v72, v72, v32
  v_add_f32 v73, v73, v33
  v_add_f32 v74, v74, v34
  v_add_f32 v75, v75, v35
  v_cvt_pk_bf16_f32 v76, v72, v73
  v_cvt_pk_bf16_f32 v77, v74, v75
  v_dot2c_f32_bf16 v252, s60, v76
  v_dot2c_f32_bf16 v253, v76, v76
  v_dot2c_f32_bf16 v252, s60, v77
  v_dot2c_f32_bf16 v253, v77, v77
  s_lshl_b32 s55, s41, 1
  s_add_u32 s55, s55, 0
  s_mul_i32 s55, s55, 18
  s_add_u32 s55, s55, s51
  s_lshl_b32 s55, s55, 10
  s_add_u32 s55, s55, s52
  s_add_u32 s55, s55, 11280384
  buffer_store_dwordx2 v[76:77], v2, s[8:11], s55 offen
  v_lshlrev_b32 v72, 16, v26
  v_and_b32 v73, 0xffff0000, v26
  v_lshlrev_b32 v74, 16, v27
  v_and_b32 v75, 0xffff0000, v27
  v_add_f32 v72, v72, v36
  v_add_f32 v73, v73, v37
  v_add_f32 v74, v74, v38
  v_add_f32 v75, v75, v39
  v_cvt_pk_bf16_f32 v78, v72, v73
  v_cvt_pk_bf16_f32 v79, v74, v75
  v_dot2c_f32_bf16 v254, s60, v78
  v_dot2c_f32_bf16 v255, v78, v78
  v_dot2c_f32_bf16 v254, s60, v79
  v_dot2c_f32_bf16 v255, v79, v79
  s_lshl_b32 s55, s41, 1
  s_add_u32 s55, s55, 1
  s_mul_i32 s55, s55, 18
  s_add_u32 s55, s55, s51
  s_lshl_b32 s55, s55, 10
  s_add_u32 s55, s55, s52
  s_add_u32 s55, s55, 11280384
  buffer_store_dwordx2 v[78:79], v2, s[8:11], s55 offen
  s_branch p2_kernel_fin
p2_kernel_no3t:
  s_waitcnt vmcnt(37)
  v_mfma_f32_16x16x32_bf16 v[32:35], a[0:3], v[108:111], 0
  v_mfma_f32_16x16x32_bf16 v[36:39], a[0:3], v[180:183], 0
  v_mfma_f32_16x16x32_bf16 v[32:35], a[4:7], v[112:115], v[32:35]
  v_mfma_f32_16x16x32_bf16 v[36:39], a[4:7], v[184:187], v[36:39]
  v_mfma_f32_16x16x32_bf16 v[32:35], a[8:11], v[116:119], v[32:35]
  v_mfma_f32_16x16x32_bf16 v[36:39], a[8:11], v[188:191], v[36:39]
  s_waitcnt vmcnt(34)
  v_mfma_f32_16x16x32_bf16 v[32:35], a[12:15], v[120:123], v[32:35]
  v_mfma_f32_16x16x32_bf16 v[36:39], a[12:15], v[192:195], v[36:39]
  v_mfma_f32_16x16x32_bf16 v[32:35], a[16:19], v[124:127], v[32:35]
  v_mfma_f32_16x16x32_bf16 v[36:39], a[16:19], v[196:199], v[36:39]
  v_mfma_f32_16x16x32_bf16 v[32:35], a[20:23], v[128:131], v[32:35]
  v_mfma_f32_16x16x32_bf16 v[36:39], a[20:23], v[200:203], v[36:39]
  s_waitcnt vmcnt(31)
  v_mfma_f32_16x16x32_bf16 v[32:35], a[24:27], v[132:135], v[32:35]
  v_mfma_f32_16x16x32_bf16 v[36:39], a[24:27], v[204:207], v[36:39]
  v_mfma_f32_16x16x32_bf16 v[32:35], a[28:31], v[136:139], v[32:35]
  v_mfma_f32_16x16x32_bf16 v[36:39], a[28:31], v[208:211], v[36:39]
  v_mfma_f32_16x16x32_bf16 v[32:35], a[32:35], v[140:143], v[32:35]
  v_mfma_f32_16x16x32_bf16 v[36:39], a[32:35], v[212:215], v[36:39]
  s_waitcnt vmcnt(28)
  v_mfma_f32_16x16x32_bf16 v[32:35], a[36:39], v[144:147], v[32:35]
  v_mfma_f32_16x16x32_bf16 v[36:39], a[36:39], v[216:219], v[36:39]
  v_mfma_f32_16x16x32_bf16 v[32:35], a[40:43], v[148:151], v[32:35]
  v_mfma_f32_16x16x32_bf16 v[36:39], a[40:43], v[220:223], v[36:39]
  v_mfma_f32_16x16x32_bf16 v[32:35], a[44:47], v[152:155], v[32:35]
  v_mfma_f32_16x16x32_bf16 v[36:39], a[44:47], v[224:227], v[36:39]
  s_waitcnt vmcnt(25)
  v_mfma_f32_16x16x32_bf16 v[32:35], a[48:51], v[156:159], v[32:35]
  v_mfma_f32_16x16x32_bf16 v[36:39], a[48:51], v[228:231], v[36:39]
  v_mfma_f32_16x16x32_bf16 v[32:35], a[52:55], v[160:163], v[32:35]
  v_mfma_f32_16x16x32_bf16 v[36:39], a[52:55], v[232:235], v[36:39]
  v_mfma_f32_16x16x32_bf16 v[32:35], a[56:59], v[164:167], v[32:35]
  v_mfma_f32_16x16x32_bf16 v[36:39], a[56:59], v[236:239], v[36:39]
  s_waitcnt vmcnt(22)
  v_mfma_f32_16x16x32_bf16 v[32:35], a[60:63], v[168:171], v[32:35]
  v_mfma_f32_16x16x32_bf16 v[36:39], a[60:63], v[240:243], v[36:39]
  v_mfma_f32_16x16x32_bf16 v[32:35], a[64:67], v[172:175], v[32:35]
  v_mfma_f32_16x16x32_bf16 v[36:39], a[64:67], v[244:247], v[36:39]
  v_mfma_f32_16x16x32_bf16 v[32:35], a[68:71], v[176:179], v[32:35]
  v_mfma_f32_16x16x32_bf16 v[36:39], a[68:71], v[248:251], v[36:39]
  s_waitcnt vmcnt(19)
  v_mfma_f32_16x16x32_bf16 v[40:43], a[72:75], v[108:111], 0
  v_mfma_f32_16x16x32_bf16 v[44:47], a[72:75], v[180:183], 0
  v_mfma_f32_16x16x32_bf16 v[40:43], a[76:79], v[112:115], v[40:43]
  v_mfma_f32_16x16x32_bf16 v[44:47], a[76:79], v[184:187], v[44:47]
  v_mfma_f32_16x16x32_bf16 v[40:43], a[80:83], v[116:119], v[40:43]
  v_mfma_f32_16x16x32_bf16 v[44:47], a[80:83], v[188:191], v[44:47]
  s_waitcnt vmcnt(16)
  v_mfma_f32_16x16x32_bf16 v[40:43], a[84:87], v[120:123], v[40:43]
  v_mfma_f32_16x16x32_bf16 v[44:47], a[84:87], v[192:195], v[44:47]
  v_mfma_f32_16x16x32_bf16 v[40:43], a[88:91], v[124:127], v[40:43]
  v_mfma_f32_16x16x32_bf16 v[44:47], a[88:91], v[196:199], v[44:47]
  v_mfma_f32_16x16x32_bf16 v[40:43], a[92:95], v[128:131], v[40:43]
  v_mfma_f32_16x16x32_bf16 v[44:47], a[92:95], v[200:203], v[44:47]
  s_waitcnt vmcnt(13)
  v_mfma_f32_16x16x32_bf16 v[40:43], a[96:99], v[132:135], v[40:43]
  v_mfma_f32_16x16x32_bf16 v[44:47], a[96:99], v[204:207], v[44:47]
  v_mfma_f32_16x16x32_bf16 v[40:43], a[100:103], v[136:139], v[40:43]
  v_mfma_f32_16x16x32_bf16 v[44:47], a[100:103], v[208:211], v[44:47]
  v_mfma_f32_16x16x32_bf16 v[40:43], a[104:107], v[140:143], v[40:43]
  v_mfma_f32_16x16x32_bf16 v[44:47], a[104:107], v[212:215], v[44:47]
  s_waitcnt vmcnt(10)
  v_mfma_f32_16x16x32_bf16 v[40:43], a[108:111], v[144:147], v[40:43]
  v_mfma_f32_16x16x32_bf16 v[44:47], a[108:111], v[216:219], v[44:47]
  v_mfma_f32_16x16x32_bf16 v[40:43], a[112:115], v[148:151], v[40:43]
  v_mfma_f32_16x16x32_bf16 v[44:47], a[112:115], v[220:223], v[44:47]
  v_mfma_f32_16x16x32_bf16 v[40:43], a[116:119], v[152:155], v[40:43]
  v_mfma_f32_16x16x32_bf16 v[44:47], a[116:119], v[224:227], v[44:47]
  s_waitcnt vmcnt(7)
  v_mfma_f32_16x16x32_bf16 v[40:43], a[120:123], v[156:159], v[40:43]
  v_mfma_f32_16x16x32_bf16 v[44:47], a[120:123], v[228:231], v[44:47]
  v_mfma_f32_16x16x32_bf16 v[40:43], a[124:127], v[160:163], v[40:43]
  v_mfma_f32_16x16x32_bf16 v[44:47], a[124:127], v[232:235], v[44:47]
  v_mfma_f32_16x16x32_bf16 v[40:43], a[128:131], v[164:167], v[40:43]
  v_mfma_f32_16x16x32_bf16 v[44:47], a[128:131], v[236:239], v[44:47]
  s_waitcnt vmcnt(4)
  v_mfma_f32_16x16x32_bf16 v[40:43], a[132:135], v[168:171], v[40:43]
  v_mfma_f32_16x16x32_bf16 v[44:47], a[132:135], v[240:243], v[44:47]
  v_mfma_f32_16x16x32_bf16 v[40:43], a[136:139], v[172:175], v[40:43]
  v_mfma_f32_16x16x32_bf16 v[44:47], a[136:139], v[244:247], v[44:47]
  v_mfma_f32_16x16x32_bf16 v[40:43], a[140:143], v[176:179], v[40:43]
  v_mfma_f32_16x16x32_bf16 v[44:47], a[140:143], v[248:251], v[44:47]
  s_waitcnt vmcnt(0)
  s_add_u32 s50, s46, 0
  s_lshr_b32 s51, s50, 1
  s_and_b32 s52, s50, 1
  s_lshl_b32 s52, s52, 3
  v_lshlrev_b32 v72, 16, v16
  v_and_b32 v73, 0xffff0000, v16
  v_lshlrev_b32 v74, 16, v17
  v_and_b32 v75, 0xffff0000, v17
  v_add_f32 v72, v72, v32
  v_add_f32 v73, v73, v33
  v_add_f32 v74, v74, v34
  v_add_f32 v75, v75, v35
  v_cvt_pk_bf16_f32 v76, v72, v73
  v_cvt_pk_bf16_f32 v77, v74, v75
  v_dot2c_f32_bf16 v252, s60, v76
  v_dot2c_f32_bf16 v253, v76, v76
  v_dot2c_f32_bf16 v252, s60, v77
  v_dot2c_f32_bf16 v253, v77, v77
  s_lshl_b32 s55, s41, 1
  s_add_u32 s55, s55, 0
  s_mul_i32 s55, s55, 18
  s_add_u32 s55, s55, s51
  s_lshl_b32 s55, s55, 10
  s_add_u32 s55, s55, s52
  s_add_u32 s55, s55, 11280384
  buffer_store_dwordx2 v[76:77], v2, s[8:11], s55 offen
  v_lshlrev_b32 v72, 16, v18
  v_and_b32 v73, 0xffff0000, v18
  v_lshlrev_b32 v74, 16, v19
  v_and_b32 v75, 0xffff0000, v19
  v_add_f32 v72, v72, v36
  v_add_f32 v73, v73, v37
  v_add_f32 v74, v74, v38
  v_add_f32 v75, v75, v39
  v_cvt_pk_bf16_f32 v78, v72, v73
  v_cvt_pk_bf16_f32 v79, v74, v75
  v_dot2c_f32_bf16 v254, s60, v78
  v_dot2c_f32_bf16 v255, v78, v78
  v_dot2c_f32_bf16 v254, s60, v79
  v_dot2c_f32_bf16 v255, v79, v79
  s_lshl_b32 s55, s41, 1
  s_add_u32 s55, s55, 1
  s_mul_i32 s55, s55, 18
  s_add_u32 s55, s55, s51
  s_lshl_b32 s55, s55, 10
  s_add_u32 s55, s55, s52
  s_add_u32 s55, s55, 11280384
  buffer_store_dwordx2 v[78:79], v2, s[8:11], s55 offen
  s_nop 7
  s_add_u32 s50, s46, 4
  s_lshr_b32 s51, s50, 1
  s_and_b32 s52, s50, 1
  s_lshl_b32 s52, s52, 3
  v_lshlrev_b32 v72, 16, v20
  v_and_b32 v73, 0xffff0000, v20
  v_lshlrev_b32 v74, 16, v21
  v_and_b32 v75, 0xffff0000, v21
  v_add_f32 v72, v72, v40
  v_add_f32 v73, v73, v41
  v_add_f32 v74, v74, v42
  v_add_f32 v75, v75, v43
  v_cvt_pk_bf16_f32 v76, v72, v73
  v_cvt_pk_bf16_f32 v77, v74, v75
  v_dot2c_f32_bf16 v252, s60, v76
  v_dot2c_f32_bf16 v253, v76, v76
  v_dot2c_f32_bf16 v252, s60, v77
  v_dot2c_f32_bf16 v253, v77, v77
  s_lshl_b32 s55, s41, 1
  s_add_u32 s55, s55, 0
  s_mul_i32 s55, s55, 18
  s_add_u32 s55, s55, s51
  s_lshl_b32 s55, s55, 10
  s_add_u32 s55, s55, s52
  s_add_u32 s55, s55, 11280384
  buffer_store_dwordx2 v[76:77], v2, s[8:11], s55 offen
  v_lshlrev_b32 v72, 16, v22
  v_and_b32 v73, 0xffff0000, v22
  v_lshlrev_b32 v74, 16, v23
  v_and_b32 v75, 0xffff0000, v23
  v_add_f32 v72, v72, v44
  v_add_f32 v73, v73, v45
  v_add_f32 v74, v74, v46
  v_add_f32 v75, v75, v47
  v_cvt_pk_bf16_f32 v78, v72, v73
  v_cvt_pk_bf16_f32 v79, v74, v75
  v_dot2c_f32_bf16 v254, s60, v78
  v_dot2c_f32_bf16 v255, v78, v78
  v_dot2c_f32_bf16 v254, s60, v79
  v_dot2c_f32_bf16 v255, v79, v79
  s_lshl_b32 s55, s41, 1
  s_add_u32 s55, s55, 1
  s_mul_i32 s55, s55, 18
  s_add_u32 s55, s55, s51
  s_lshl_b32 s55, s55, 10
  s_add_u32 s55, s55, s52
  s_add_u32 s55, s55, 11280384
  buffer_store_dwordx2 v[78:79], v2, s[8:11], s55 offen
p2_kernel_fin:
  s_getpc_b64 s[62:63]
p2_kernel_cpf:
  s_add_u32 s62, s62, ffn_kernel-p2_kernel_cpf
  s_addc_u32 s63, s63, 0
  v_lshlrev_b32 v12, 7, v1
  v_add_u32 v12, 0, v12
  v_cmp_gt_u32 vcc, red_kernel-ffn_kernel, v12
  v_mov_b32 v13, 0
  s_nop 0
  v_cndmask_b32 v12, v13, v12, vcc
  global_load_dword v13, v12, s[62:63]
  v_lshlrev_b32 v12, 7, v1
  v_add_u32 v12, 8192, v12
  v_cmp_gt_u32 vcc, red_kernel-ffn_kernel, v12
  v_mov_b32 v13, 0
  s_nop 0
  v_cndmask_b32 v12, v13, v12, vcc
  global_load_dword v13, v12, s[62:63]
  s_nop 2
  v_mov_b32 v72, v252
  v_mov_b32 v73, v253
  v_mov_b32 v74, v254
  v_mov_b32 v75, v255
  s_nop 1
  v_permlane32_swap_b32 v252, v72
  v_permlane32_swap_b32 v253, v73
  v_permlane32_swap_b32 v254, v74
  v_permlane32_swap_b32 v255, v75
  s_nop 1
  v_add_f32 v252, v252, v72
  v_add_f32 v253, v253, v73
  v_add_f32 v254, v254, v74
  v_add_f32 v255, v255, v75
  v_mov_b32 v72, v252
  v_mov_b32 v73, v253
  v_mov_b32 v74, v254
  v_mov_b32 v75, v255
  s_nop 1
  v_permlane16_swap_b32 v252, v72
  v_permlane16_swap_b32 v253, v73
  v_permlane16_swap_b32 v254, v74
  v_permlane16_swap_b32 v255, v75
  s_nop 1
  v_add_f32 v252, v252, v72
  v_add_f32 v253, v253, v73
  v_add_f32 v254, v254, v74
  v_add_f32 v255, v255, v75
  v_and_b32 v72, 15, v1
  v_lshlrev_b32 v72, 7, v72
  v_cmp_gt_u32 vcc, 16, v1
  v_mov_b32 v73, 0x7fff0000
  s_nop 0
  v_cndmask_b32 v72, v73, v72, vcc
  s_lshl_b32 s50, s41, 12
  s_lshl_b32 s51, s42, 2
  s_add_u32 s51, s51, s40
  s_lshl_b32 s51, s51, 3
  s_add_u32 s50, s50, s51
  s_add_u32 s50, s50, 37347328
  buffer_store_dwordx2 v[252:253], v72, s[8:11], s50 offen
  buffer_store_dwordx2 v[254:255], v72, s[8:11], s50 offen offset:2048
p2_kernel_end:
  s_endpgm
.globl ffn_kernel
.p2align 8
.type ffn_kernel,@function
ffn_kernel:
  s_cmp_ge_u32 s2, 256
  s_cbranch_scc1 ffn_kernel_end
  s_load_dwordx2 s[4:5], s[0:1], 88
  s_load_dwordx2 s[6:7], s[0:1], 48
  v_and_b32 v1, 63, v0
  v_lshrrev_b32 v15, 6, v0
  s_nop 0
  v_readfirstlane_b32 s40, v15
  s_and_b32 s53, s2, 7
  s_lshr_b32 s54, s2, 3
  s_lshr_b32 s55, s53, 1
  s_lshl_b32 s55, s55, 3
  s_and_b32 s56, s54, 7
  s_add_u32 s42, s55, s56
  s_and_b32 s55, s53, 1
  s_lshl_b32 s55, s55, 2
  s_lshr_b32 s57, s54, 3
  s_add_u32 s41, s55, s57
  s_mov_b32 s49, s56
  s_mov_b32 s49, 0
  v_lshlrev_b32 v7, 4, v1
  v_add_u32 v8, 0x10000, v7
  s_mul_i32 s50, s40, 18432
  v_add_u32 v2, s50, v7
  v_add_u32 v3, 4096, v2
  v_add_u32 v4, 8192, v2
  v_add_u32 v5, 12288, v2
  v_add_u32 v6, 16384, v2
  s_and_b32 s50, s40, 1
  s_lshl_b32 s50, s50, 3
  s_lshr_b32 s51, s40, 1
  s_lshl_b32 s51, s51, 12
  s_add_u32 s50, s50, s51
  v_add_u32 v14, s50, v7
  s_lshl_b32 s50, s40, 11
  v_add_u32 v10, s50, v7
  v_lshrrev_b32 v15, 4, v1
  v_lshlrev_b32 v15, 3, v15
  s_lshl_b32 s50, s40, 5
  v_add_u32 v11, s50, v15
  v_mov_b32 v12, 0xc0135761
  v_mov_b32 v13, 0xbdd2d3e8
  s_mov_b32 s63, 0xffff0000
  s_waitcnt lgkmcnt(0)
  s_mov_b32 s8, s4
  s_and_b32 s9, s5, 0xffff
  s_mov_b32 s10, 39313408
  s_mov_b32 s11, 0x20000
  s_mov_b32 s12, s6
  s_and_b32 s13, s7, 0xffff
  s_mov_b32 s14, 9216
  s_mov_b32 s15, 0x20000
  v_and_b32 v15, 15, v1
  v_lshlrev_b32 v15, 7, v15
  v_lshrrev_b32 v32, 4, v1
  v_lshl_add_u32 v15, v32, 5, v15
  s_lshl_b32 s50, s42, 2
  s_add_u32 s50, s50, s40
  s_lshl_b32 s51, s50, 11
  s_add_u32 s51, s51, 37347328
  buffer_load_dwordx4 v[48:51], v15, s[8:11], s51 offen
  buffer_load_dwordx4 v[52:55], v15, s[8:11], s51 offen offset:16
  s_mul_i32 s50, s50, 18432
  s_add_u32 s66, s50, 11280384
  s_add_u32 s50, s66, 0
  buffer_load_dwordx4 v[152:155], v7, s[8:11], s50 offen offset:0
  s_add_u32 s50, s66, 0
  buffer_load_dwordx4 v[156:159], v7, s[8:11], s50 offen offset:1024
  s_add_u32 s50, s66, 0
  buffer_load_dwordx4 v[160:163], v7, s[8:11], s50 offen offset:2048
  s_add_u32 s50, s66, 0
  buffer_load_dwordx4 v[164:167], v7, s[8:11], s50 offen offset:3072
  s_add_u32 s50, s66, 4096
  buffer_load_dwordx4 v[168:171], v7, s[8:11], s50 offen offset:0
  s_add_u32 s50, s66, 4096
  buffer_load_dwordx4 v[172:175], v7, s[8:11], s50 offen offset:1024
  s_add_u32 s50, s66, 4096
  buffer_load_dwordx4 v[176:179], v7, s[8:11], s50 offen offset:2048
  s_add_u32 s50, s66, 4096
  buffer_load_dwordx4 v[180:183], v7, s[8:11], s50 offen offset:3072
  s_mul_i32 s51, s41, 663552
  s_add_u32 s58, s51, 0
  s_add_u32 s48, s51, 5308416
  s_mul_i32 s61, s41, 1152
  s_lshl_b32 s50, s42, 3
  s_add_u32 s50, s50, s41
  s_mul_i32 s50, s50, 73728
  s_add_u32 s60, s50, 13639680
  s_mul_i32 s50, s49, 73728
  s_add_u32 s44, s58, s50
  s_add_u32 s59, s49, 1
  s_cmp_eq_u32 s59, 9
  s_cselect_b32 s59, 0, s59
  s_mul_i32 s50, s59, 73728
  s_add_u32 s45, s58, s50
  s_lshl_b32 s50, s49, 7
  s_add_u32 s47, s61, s50
  buffer_load_dwordx2 v[76:77], v11, s[12:15], s47 offen
  s_waitcnt vmcnt(9)
  v_add_f32 v16, v48, v50
  v_add_f32 v18, v49, v51
  v_add_f32 v17, v52, v54
  v_add_f32 v19, v53, v55
  v_add_f32 v16, v16, v17
  v_add_f32 v18, v18, v19
  v_mov_b32 v17, v16
  v_mov_b32 v19, v18
  s_nop 1
  v_permlane32_swap_b32 v16, v17
  v_permlane32_swap_b32 v18, v19
  s_nop 1
  v_add_f32 v16, v16, v17
  v_add_f32 v18, v18, v19
  v_mov_b32 v17, v16
  v_mov_b32 v19, v18
  s_nop 1
  v_permlane16_swap_b32 v16, v17
  v_permlane16_swap_b32 v18, v19
  s_nop 1
  v_add_f32 v16, v16, v17
  v_add_f32 v18, v18, v19
  v_mul_f32 v16, 0x3ae38e39, v16
  v_mul_f32 v18, 0x3ae38e39, v18
  v_fma_f32 v18, -v16, v16, v18
  v_max_f32 v18, 0, v18
  v_add_f32 v18, 0x3727c5ac, v18
  v_rsq_f32 v20, v18
  s_nop 0
  v_mul_f32 v22, v16, v20
  v_sub_f32 v22, 0, v22
  v_mov_b32 v21, v20
  v_mov_b32 v23, v22
  s_lshl_b32 s50, s40, 10
  v_add_u32 v9, s50, v7
  v_add_u32 v15, 0x10000, v9
  s_add_u32 s50, s66, 8192
  buffer_load_dwordx4 v[184:187], v7, s[8:11], s50 offen offset:0
  s_waitcnt vmcnt(9)
  v_lshlrev_b32 v32, 16, v152
  v_and_b32 v33, s63, v152
  v_lshlrev_b32 v34, 16, v153
  v_and_b32 v35, s63, v153
  v_lshlrev_b32 v36, 16, v154
  v_and_b32 v37, s63, v154
  v_lshlrev_b32 v38, 16, v155
  v_and_b32 v39, s63, v155
  buffer_load_dwordx4 v[80:83], v2, s[8:11], s44 offen offset:0
  v_pk_fma_f32 v[32:33], v[32:33], v[20:21], v[22:23]
  v_pk_fma_f32 v[34:35], v[34:35], v[20:21], v[22:23]
  v_pk_fma_f32 v[36:37], v[36:37], v[20:21], v[22:23]
  v_pk_fma_f32 v[38:39], v[38:39], v[20:21], v[22:23]
  v_cvt_pk_bf16_f32 v152, v32, v33
  v_cvt_pk_bf16_f32 v153, v34, v35
  v_cvt_pk_bf16_f32 v154, v36, v37
  v_cvt_pk_bf16_f32 v155, v38, v39
  ds_write_b128 v9, v[152:155] offset:0
  s_add_u32 s50, s66, 8192
  buffer_load_dwordx4 v[188:191], v7, s[8:11], s50 offen offset:1024
  s_waitcnt vmcnt(10)
  v_lshlrev_b32 v40, 16, v156
  v_and_b32 v41, s63, v156
  v_lshlrev_b32 v42, 16, v157
  v_and_b32 v43, s63, v157
  v_lshlrev_b32 v44, 16, v158
  v_and_b32 v45, s63, v158
  v_lshlrev_b32 v46, 16, v159
  v_and_b32 v47, s63, v159
  buffer_load_dwordx4 v[84:87], v2, s[8:11], s44 offen offset:1024
  v_pk_fma_f32 v[40:41], v[40:41], v[20:21], v[22:23]
  v_pk_fma_f32 v[42:43], v[42:43], v[20:21], v[22:23]
  v_pk_fma_f32 v[44:45], v[44:45], v[20:21], v[22:23]
  v_pk_fma_f32 v[46:47], v[46:47], v[20:21], v[22:23]
  v_cvt_pk_bf16_f32 v156, v40, v41
  v_cvt_pk_bf16_f32 v157, v42, v43
  v_cvt_pk_bf16_f32 v158, v44, v45
  v_cvt_pk_bf16_f32 v159, v46, v47
  ds_write_b128 v9, v[156:159] offset:4096
  s_add_u32 s50, s66, 8192
  buffer_load_dwordx4 v[192:195], v7, s[8:11], s50 offen offset:2048
  s_waitcnt vmcnt(11)
  v_lshlrev_b32 v32, 16, v160
  v_and_b32 v33, s63, v160
  v_lshlrev_b32 v34, 16, v161
  v_and_b32 v35, s63, v161
  v_lshlrev_b32 v36, 16, v162
  v_and_b32 v37, s63, v162
  v_lshlrev_b32 v38, 16, v163
  v_and_b32 v39, s63, v163
  buffer_load_dwordx4 v[88:91], v2, s[8:11], s44 offen offset:2048
  v_pk_fma_f32 v[32:33], v[32:33], v[20:21], v[22:23]
  v_pk_fma_f32 v[34:35], v[34:35], v[20:21], v[22:23]
  v_pk_fma_f32 v[36:37], v[36:37], v[20:21], v[22:23]
  v_pk_fma_f32 v[38:39], v[38:39], v[20:21], v[22:23]
  v_cvt_pk_bf16_f32 v160, v32, v33
  v_cvt_pk_bf16_f32 v161, v34, v35
  v_cvt_pk_bf16_f32 v162, v36, v37
  v_cvt_pk_bf16_f32 v163, v38, v39
  ds_write_b128 v9, v[160:163] offset:8192
  s_add_u32 s50, s66, 8192
  buffer_load_dwordx4 v[196:199], v7, s[8:11], s50 offen offset:3072
  s_waitcnt vmcnt(12)
  v_lshlrev_b32 v40, 16, v164
  v_and_b32 v41, s63, v164
  v_lshlrev_b32 v42, 16, v165
  v_and_b32 v43, s63, v165
  v_lshlrev_b32 v44, 16, v166
  v_and_b32 v45, s63, v166
  v_lshlrev_b32 v46, 16, v167
  v_and_b32 v47, s63, v167
  buffer_load_dwordx4 v[92:95], v2, s[8:11], s44 offen offset:3072
  v_pk_fma_f32 v[40:41], v[40:41], v[20:21], v[22:23]
  v_pk_fma_f32 v[42:43], v[42:43], v[20:21], v[22:23]
  v_pk_fma_f32 v[44:45], v[44:45], v[20:21], v[22:23]
  v_pk_fma_f32 v[46:47], v[46:47], v[20:21], v[22:23]
  v_cvt_pk_bf16_f32 v164, v40, v41
  v_cvt_pk_bf16_f32 v165, v42, v43
  v_cvt_pk_bf16_f32 v166, v44, v45
  v_cvt_pk_bf16_f32 v167, v46, v47
  ds_write_b128 v9, v[164:167] offset:12288
  s_add_u32 s50, s66, 12288
  buffer_load_dwordx4 v[200:203], v7, s[8:11], s50 offen offset:0
  s_waitcnt vmcnt(13)
  v_lshlrev_b32 v32, 16, v168
  v_and_b32 v33, s63, v168
  v_lshlrev_b32 v34, 16, v169
  v_and_b32 v35, s63, v169
  v_lshlrev_b32 v36, 16, v170
  v_and_b32 v37, s63, v170
  v_lshlrev_b32 v38, 16, v171
  v_and_b32 v39, s63, v171
  buffer_load_dwordx4 v[96:99], v3, s[8:11], s44 offen offset:0
  v_pk_fma_f32 v[32:33], v[32:33], v[20:21], v[22:23]
  v_pk_fma_f32 v[34:35], v[34:35], v[20:21], v[22:23]
  v_pk_fma_f32 v[36:37], v[36:37], v[20:21], v[22:23]
  v_pk_fma_f32 v[38:39], v[38:39], v[20:21], v[22:23]
  v_cvt_pk_bf16_f32 v168, v32, v33
  v_cvt_pk_bf16_f32 v169, v34, v35
  v_cvt_pk_bf16_f32 v170, v36, v37
  v_cvt_pk_bf16_f32 v171, v38, v39
  ds_write_b128 v9, v[168:171] offset:16384
  s_add_u32 s50, s66, 12288
  buffer_load_dwordx4 v[204:207], v7, s[8:11], s50 offen offset:1024
  s_waitcnt vmcnt(14)
  v_lshlrev_b32 v40, 16, v172
  v_and_b32 v41, s63, v172
  v_lshlrev_b32 v42, 16, v173
  v_and_b32 v43, s63, v173
  v_lshlrev_b32 v44, 16, v174
  v_and_b32 v45, s63, v174
  v_lshlrev_b32 v46, 16, v175
  v_and_b32 v47, s63, v175
  buffer_load_dwordx4 v[100:103], v3, s[8:11], s44 offen offset:1024
  v_pk_fma_f32 v[40:41], v[40:41], v[20:21], v[22:23]
  v_pk_fma_f32 v[42:43], v[42:43], v[20:21], v[22:23]
  v_pk_fma_f32 v[44:45], v[44:45], v[20:21], v[22:23]
  v_pk_fma_f32 v[46:47], v[46:47], v[20:21], v[22:23]
  v_cvt_pk_bf16_f32 v172, v40, v41
  v_cvt_pk_bf16_f32 v173, v42, v43
  v_cvt_pk_bf16_f32 v174, v44, v45
  v_cvt_pk_bf16_f32 v175, v46, v47
  ds_write_b128 v9, v[172:175] offset:20480
  s_add_u32 s50, s66, 12288
  buffer_load_dwordx4 v[208:211], v7, s[8:11], s50 offen offset:2048
  s_waitcnt vmcnt(15)
  v_lshlrev_b32 v32, 16, v176
  v_and_b32 v33, s63, v176
  v_lshlrev_b32 v34, 16, v177
  v_and_b32 v35, s63, v177
  v_lshlrev_b32 v36, 16, v178
  v_and_b32 v37, s63, v178
  v_lshlrev_b32 v38, 16, v179
  v_and_b32 v39, s63, v179
  buffer_load_dwordx4 v[104:107], v3, s[8:11], s44 offen offset:2048
  v_pk_fma_f32 v[32:33], v[32:33], v[20:21], v[22:23]
  v_pk_fma_f32 v[34:35], v[34:35], v[20:21], v[22:23]
  v_pk_fma_f32 v[36:37], v[36:37], v[20:21], v[22:23]
  v_pk_fma_f32 v[38:39], v[38:39], v[20:21], v[22:23]
  v_cvt_pk_bf16_f32 v176, v32, v33
  v_cvt_pk_bf16_f32 v177, v34, v35
  v_cvt_pk_bf16_f32 v178, v36, v37
  v_cvt_pk_bf16_f32 v179, v38, v39
  ds_write_b128 v9, v[176:179] offset:24576
  s_add_u32 s50, s66, 12288
  buffer_load_dwordx4 v[212:215], v7, s[8:11], s50 offen offset:3072
  s_waitcnt vmcnt(16)
  v_lshlrev_b32 v40, 16, v180
  v_and_b32 v41, s63, v180
  v_lshlrev_b32 v42, 16, v181
  v_and_b32 v43, s63, v181
  v_lshlrev_b32 v44, 16, v182
  v_and_b32 v45, s63, v182
  v_lshlrev_b32 v46, 16, v183
  v_and_b32 v47, s63, v183
  buffer_load_dwordx4 v[108:111], v3, s[8:11], s44 offen offset:3072
  v_pk_fma_f32 v[40:41], v[40:41], v[20:21], v[22:23]
  v_pk_fma_f32 v[42:43], v[42:43], v[20:21], v[22:23]
  v_pk_fma_f32 v[44:45], v[44:45], v[20:21], v[22:23]
  v_pk_fma_f32 v[46:47], v[46:47], v[20:21], v[22:23]
  v_cvt_pk_bf16_f32 v180, v40, v41
  v_cvt_pk_bf16_f32 v181, v42, v43
  v_cvt_pk_bf16_f32 v182, v44, v45
  v_cvt_pk_bf16_f32 v183, v46, v47
  ds_write_b128 v9, v[180:183] offset:28672
  s_add_u32 s50, s66, 16384
  buffer_load_dwordx4 v[216:219], v7, s[8:11], s50 offen offset:0
  s_waitcnt vmcnt(16)
  v_lshlrev_b32 v32, 16, v184
  v_and_b32 v33, s63, v184
  v_lshlrev_b32 v34, 16, v185
  v_and_b32 v35, s63, v185
  v_lshlrev_b32 v36, 16, v186
  v_and_b32 v37, s63, v186
  v_lshlrev_b32 v38, 16, v187
  v_and_b32 v39, s63, v187
  buffer_load_dwordx4 v[112:115], v4, s[8:11], s44 offen offset:0
  v_pk_fma_f32 v[32:33], v[32:33], v[20:21], v[22:23]
  v_pk_fma_f32 v[34:35], v[34:35], v[20:21], v[22:23]
  v_pk_fma_f32 v[36:37], v[36:37], v[20:21], v[22:23]
  v_pk_fma_f32 v[38:39], v[38:39], v[20:21], v[22:23]
  v_cvt_pk_bf16_f32 v184, v32, v33
  v_cvt_pk_bf16_f32 v185, v34, v35
  v_cvt_pk_bf16_f32 v186, v36, v37
  v_cvt_pk_bf16_f32 v187, v38, v39
  ds_write_b128 v9, v[184:187] offset:32768
  s_add_u32 s50, s66, 16384
  buffer_load_dwordx4 v[220:223], v7, s[8:11], s50 offen offset:1024
  s_waitcnt vmcnt(16)
  v_lshlrev_b32 v40, 16, v188
  v_and_b32 v41, s63, v188
  v_lshlrev_b32 v42, 16, v189
  v_and_b32 v43, s63, v189
  v_lshlrev_b32 v44, 16, v190
  v_and_b32 v45, s63, v190
  v_lshlrev_b32 v46, 16, v191
  v_and_b32 v47, s63, v191
  buffer_load_dwordx4 v[116:119], v4, s[8:11], s44 offen offset:1024
  v_pk_fma_f32 v[40:41], v[40:41], v[20:21], v[22:23]
  v_pk_fma_f32 v[42:43], v[42:43], v[20:21], v[22:23]
  v_pk_fma_f32 v[44:45], v[44:45], v[20:21], v[22:23]
  v_pk_fma_f32 v[46:47], v[46:47], v[20:21], v[22:23]
  v_cvt_pk_bf16_f32 v188, v40, v41
  v_cvt_pk_bf16_f32 v189, v42, v43
  v_cvt_pk_bf16_f32 v190, v44, v45
  v_cvt_pk_bf16_f32 v191, v46, v47
  ds_write_b128 v9, v[188:191] offset:36864
  s_waitcnt vmcnt(15)
  v_lshlrev_b32 v32, 16, v192
  v_and_b32 v33, s63, v192
  v_lshlrev_b32 v34, 16, v193
  v_and_b32 v35, s63, v193
  v_lshlrev_b32 v36, 16, v194
  v_and_b32 v37, s63, v194
  v_lshlrev_b32 v38, 16, v195
  v_and_b32 v39, s63, v195
  buffer_load_dwordx4 v[120:123], v4, s[8:11], s44 offen offset:2048
  v_pk_fma_f32 v[32:33], v[32:33], v[20:21], v[22:23]
  v_pk_fma_f32 v[34:35], v[34:35], v[20:21], v[22:23]
  v_pk_fma_f32 v[36:37], v[36:37], v[20:21], v[22:23]
  v_pk_fma_f32 v[38:39], v[38:39], v[20:21], v[22:23]
  v_cvt_pk_bf16_f32 v192, v32, v33
  v_cvt_pk_bf16_f32 v193, v34, v35
  v_cvt_pk_bf16_f32 v194, v36, v37
  v_cvt_pk_bf16_f32 v195, v38, v39
  ds_write_b128 v9, v[192:195] offset:40960
  s_waitcnt vmcnt(14)
  v_lshlrev_b32 v40, 16, v196
  v_and_b32 v41, s63, v196
  v_lshlrev_b32 v42, 16, v197
  v_and_b32 v43, s63, v197
  v_lshlrev_b32 v44, 16, v198
  v_and_b32 v45, s63, v198
  v_lshlrev_b32 v46, 16, v199
  v_and_b32 v47, s63, v199
  buffer_load_dwordx4 v[124:127], v4, s[8:11], s44 offen offset:3072
  v_pk_fma_f32 v[40:41], v[40:41], v[20:21], v[22:23]
  v_pk_fma_f32 v[42:43], v[42:43], v[20:21], v[22:23]
  v_pk_fma_f32 v[44:45], v[44:45], v[20:21], v[22:23]
  v_pk_fma_f32 v[46:47], v[46:47], v[20:21], v[22:23]
  v_cvt_pk_bf16_f32 v196, v40, v41
  v_cvt_pk_bf16_f32 v197, v42, v43
  v_cvt_pk_bf16_f32 v198, v44, v45
  v_cvt_pk_bf16_f32 v199, v46, v47
  ds_write_b128 v9, v[196:199] offset:45056
  s_waitcnt vmcnt(13)
  v_lshlrev_b32 v32, 16, v200
  v_and_b32 v33, s63, v200
  v_lshlrev_b32 v34, 16, v201
  v_and_b32 v35, s63, v201
  v_lshlrev_b32 v36, 16, v202
  v_and_b32 v37, s63, v202
  v_lshlrev_b32 v38, 16, v203
  v_and_b32 v39, s63, v203
  buffer_load_dwordx4 v[128:131], v5, s[8:11], s44 offen offset:0
  v_pk_fma_f32 v[32:33], v[32:33], v[20:21], v[22:23]
  v_pk_fma_f32 v[34:35], v[34:35], v[20:21], v[22:23]
  v_pk_fma_f32 v[36:37], v[36:37], v[20:21], v[22:23]
  v_pk_fma_f32 v[38:39], v[38:39], v[20:21], v[22:23]
  v_cvt_pk_bf16_f32 v200, v32, v33
  v_cvt_pk_bf16_f32 v201, v34, v35
  v_cvt_pk_bf16_f32 v202, v36, v37
  v_cvt_pk_bf16_f32 v203, v38, v39
  ds_write_b128 v9, v[200:203] offset:49152
  s_waitcnt vmcnt(12)
  v_lshlrev_b32 v40, 16, v204
  v_and_b32 v41, s63, v204
  v_lshlrev_b32 v42, 16, v205
  v_and_b32 v43, s63, v205
  v_lshlrev_b32 v44, 16, v206
  v_and_b32 v45, s63, v206
  v_lshlrev_b32 v46, 16, v207
  v_and_b32 v47, s63, v207
  buffer_load_dwordx4 v[132:135], v5, s[8:11], s44 offen offset:1024
  v_pk_fma_f32 v[40:41], v[40:41], v[20:21], v[22:23]
  v_pk_fma_f32 v[42:43], v[42:43], v[20:21], v[22:23]
  v_pk_fma_f32 v[44:45], v[44:45], v[20:21], v[22:23]
  v_pk_fma_f32 v[46:47], v[46:47], v[20:21], v[22:23]
  v_cvt_pk_bf16_f32 v204, v40, v41
  v_cvt_pk_bf16_f32 v205, v42, v43
  v_cvt_pk_bf16_f32 v206, v44, v45
  v_cvt_pk_bf16_f32 v207, v46, v47
  ds_write_b128 v9, v[204:207] offset:53248
  s_waitcnt vmcnt(11)
  v_lshlrev_b32 v32, 16, v208
  v_and_b32 v33, s63, v208
  v_lshlrev_b32 v34, 16, v209
  v_and_b32 v35, s63, v209
  v_lshlrev_b32 v36, 16, v210
  v_and_b32 v37, s63, v210
  v_lshlrev_b32 v38, 16, v211
  v_and_b32 v39, s63, v211
  buffer_load_dwordx4 v[136:139], v5, s[8:11], s44 offen offset:2048
  v_pk_fma_f32 v[32:33], v[32:33], v[20:21], v[22:23]
  v_pk_fma_f32 v[34:35], v[34:35], v[20:21], v[22:23]
  v_pk_fma_f32 v[36:37], v[36:37], v[20:21], v[22:23]
  v_pk_fma_f32 v[38:39], v[38:39], v[20:21], v[22:23]
  v_cvt_pk_bf16_f32 v208, v32, v33
  v_cvt_pk_bf16_f32 v209, v34, v35
  v_cvt_pk_bf16_f32 v210, v36, v37
  v_cvt_pk_bf16_f32 v211, v38, v39
  ds_write_b128 v9, v[208:211] offset:57344
  s_waitcnt vmcnt(10)
  v_lshlrev_b32 v40, 16, v212
  v_and_b32 v41, s63, v212
  v_lshlrev_b32 v42, 16, v213
  v_and_b32 v43, s63, v213
  v_lshlrev_b32 v44, 16, v214
  v_and_b32 v45, s63, v214
  v_lshlrev_b32 v46, 16, v215
  v_and_b32 v47, s63, v215
  buffer_load_dwordx4 v[140:143], v5, s[8:11], s44 offen offset:3072
  v_pk_fma_f32 v[40:41], v[40:41], v[20:21], v[22:23]
  v_pk_fma_f32 v[42:43], v[42:43], v[20:21], v[22:23]
  v_pk_fma_f32 v[44:45], v[44:45], v[20:21], v[22:23]
  v_pk_fma_f32 v[46:47], v[46:47], v[20:21], v[22:23]
  v_cvt_pk_bf16_f32 v212, v40, v41
  v_cvt_pk_bf16_f32 v213, v42, v43
  v_cvt_pk_bf16_f32 v214, v44, v45
  v_cvt_pk_bf16_f32 v215, v46, v47
  ds_write_b128 v9, v[212:215] offset:61440
  s_waitcnt vmcnt(9)
  v_lshlrev_b32 v32, 16, v216
  v_and_b32 v33, s63, v216
  v_lshlrev_b32 v34, 16, v217
  v_and_b32 v35, s63, v217
  v_lshlrev_b32 v36, 16, v218
  v_and_b32 v37, s63, v218
  v_lshlrev_b32 v38, 16, v219
  v_and_b32 v39, s63, v219
  buffer_load_dwordx4 v[144:147], v6, s[8:11], s44 offen offset:0
  v_pk_fma_f32 v[32:33], v[32:33], v[20:21], v[22:23]
  v_pk_fma_f32 v[34:35], v[34:35], v[20:21], v[22:23]
  v_pk_fma_f32 v[36:37], v[36:37], v[20:21], v[22:23]
  v_pk_fma_f32 v[38:39], v[38:39], v[20:21], v[22:23]
  v_cvt_pk_bf16_f32 v216, v32, v33
  v_cvt_pk_bf16_f32 v217, v34, v35
  v_cvt_pk_bf16_f32 v218, v36, v37
  v_cvt_pk_bf16_f32 v219, v38, v39
  ds_write_b128 v15, v[216:219] offset:0
  s_waitcnt vmcnt(8)
  v_lshlrev_b32 v40, 16, v220
  v_and_b32 v41, s63, v220
  v_lshlrev_b32 v42, 16, v221
  v_and_b32 v43, s63, v221
  v_lshlrev_b32 v44, 16, v222
  v_and_b32 v45, s63, v222
  v_lshlrev_b32 v46, 16, v223
  v_and_b32 v47, s63, v223
  v_pk_fma_f32 v[40:41], v[40:41], v[20:21], v[22:23]
  v_pk_fma_f32 v[42:43], v[42:43], v[20:21], v[22:23]
  v_pk_fma_f32 v[44:45], v[44:45], v[20:21], v[22:23]
  v_pk_fma_f32 v[46:47], v[46:47], v[20:21], v[22:23]
  v_cvt_pk_bf16_f32 v220, v40, v41
  v_cvt_pk_bf16_f32 v221, v42, v43
  v_cvt_pk_bf16_f32 v222, v44, v45
  v_cvt_pk_bf16_f32 v223, v46, v47
  ds_write_b128 v15, v[220:223] offset:4096
  s_waitcnt lgkmcnt(0)
  s_barrier
  s_lshl_b32 s50, s59, 7
  s_add_u32 s47, s61, s50
  ds_read_b128 a[0:3], v7 offset:0
  ds_read_b128 a[4:7], v7 offset:1024
  ds_read_b128 a[8:11], v7 offset:2048
  ds_read_b128 a[12:15], v7 offset:3072
  ds_read_b128 a[16:19], v7 offset:4096
  ds_read_b128 a[20:23], v7 offset:5120
  ds_read_b128 a[24:27], v7 offset:6144
  ds_read_b128 a[28:31], v7 offset:7168
  ds_read_b128 a[32:35], v7 offset:8192
  ds_read_b128 a[36:39], v7 offset:9216
  ds_read_b128 a[40:43], v7 offset:10240
  ds_read_b128 a[44:47], v7 offset:11264
  s_waitcnt vmcnt(16) lgkmcnt(8)
  v_lshlrev_b32 v72, 16, v76
  v_and_b32 v73, s63, v76
  v_lshlrev_b32 v74, 16, v77
  v_and_b32 v75, s63, v77
  s_nop 1
  v_mfma_f32_16x16x32_bf16 v[16:19], v[80:83], a[0:3], v[72:75]
  buffer_load_dwordx4 v[148:151], v6, s[8:11], s44 offen offset:1024
  v_mfma_f32_16x16x32_bf16 v[20:23], v[80:83], a[4:7], v[72:75]
  ds_read_b128 a[48:51], v7 offset:12288
  ds_read_b128 a[52:55], v7 offset:13312
  ds_read_b128 a[56:59], v7 offset:14336
  ds_read_b128 a[60:63], v7 offset:15360
  v_mfma_f32_16x16x32_bf16 v[24:27], v[80:83], a[8:11], v[72:75]
  v_mfma_f32_16x16x32_bf16 v[28:31], v[80:83], a[12:15], v[72:75]
  s_waitcnt vmcnt(16) lgkmcnt(8)
  v_mfma_f32_16x16x32_bf16 v[16:19], v[84:87], a[16:19], v[16:19]
  buffer_load_dwordx2 v[76:77], v11, s[12:15], s47 offen
  buffer_load_dwordx4 v[80:83], v2, s[8:11], s45 offen offset:0
  v_mfma_f32_16x16x32_bf16 v[20:23], v[84:87], a[20:23], v[20:23]
  ds_read_b128 a[64:67], v7 offset:16384
  ds_read_b128 a[68:71], v7 offset:17408
  ds_read_b128 a[72:75], v7 offset:18432
  ds_read_b128 a[76:79], v7 offset:19456
  v_mfma_f32_16x16x32_bf16 v[24:27], v[84:87], a[24:27], v[24:27]
  v_mfma_f32_16x16x32_bf16 v[28:31], v[84:87], a[28:31], v[28:31]
  s_waitcnt vmcnt(17) lgkmcnt(8)
  v_mfma_f32_16x16x32_bf16 v[16:19], v[88:91], a[32:35], v[16:19]
  buffer_load_dwordx4 v[84:87], v2, s[8:11], s45 offen offset:1024
  v_mfma_f32_16x16x32_bf16 v[20:23], v[88:91], a[36:39], v[20:23]
  ds_read_b128 a[80:83], v7 offset:20480
  ds_read_b128 a[84:87], v7 offset:21504
  ds_read_b128 a[88:91], v7 offset:22528
  ds_read_b128 a[92:95], v7 offset:23552
  v_mfma_f32_16x16x32_bf16 v[24:27], v[88:91], a[40:43], v[24:27]
  v_mfma_f32_16x16x32_bf16 v[28:31], v[88:91], a[44:47], v[28:31]
  s_waitcnt vmcnt(17) lgkmcnt(8)
  v_mfma_f32_16x16x32_bf16 v[16:19], v[92:95], a[48:51], v[16:19]
  buffer_load_dwordx4 v[88:91], v2, s[8:11], s45 offen offset:2048
  v_mfma_f32_16x16x32_bf16 v[20:23], v[92:95], a[52:55], v[20:23]
  ds_read_b128 a[96:99], v7 offset:24576
  ds_read_b128 a[100:103], v7 offset:25600
  ds_read_b128 a[104:107], v7 offset:26624
  ds_read_b128 a[108:111], v7 offset:27648
  v_mfma_f32_16x16x32_bf16 v[24:27], v[92:95], a[56:59], v[24:27]
  v_mfma_f32_16x16x32_bf16 v[28:31], v[92:95], a[60:63], v[28:31]
  s_waitcnt vmcnt(17) lgkmcnt(8)
  v_mfma_f32_16x16x32_bf16 v[16:19], v[96:99], a[64:67], v[16:19]
  buffer_load_dwordx4 v[92:95], v2, s[8:11], s45 offen offset:3072
  v_mfma_f32_16x16x32_bf16 v[20:23], v[96:99], a[68:71], v[20:23]
  ds_read_b128 a[112:115], v7 offset:28672
  ds_read_b128 a[116:119], v7 offset:29696
  ds_read_b128 a[120:123], v7 offset:30720
  ds_read_b128 a[124:127], v7 offset:31744
  v_mfma_f32_16x16x32_bf16 v[24:27], v[96:99], a[72:75], v[24:27]
  v_mfma_f32_16x16x32_bf16 v[28:31], v[96:99], a[76:79], v[28:31]
  s_waitcnt vmcnt(17) lgkmcnt(8)
  v_mfma_f32_16x16x32_bf16 v[16:19], v[100:103], a[80:83], v[16:19]
  buffer_load_dwordx4 v[96:99], v3, s[8:11], s45 offen offset:0
  v_mfma_f32_16x16x32_bf16 v[20:23], v[100:103], a[84:87], v[20:23]
  ds_read_b128 a[128:131], v7 offset:32768
  ds_read_b128 a[132:135], v7 offset:33792
  ds_read_b128 a[136:139], v7 offset:34816
  ds_read_b128 a[140:143], v7 offset:35840
  v_mfma_f32_16x16x32_bf16 v[24:27], v[100:103], a[88:91], v[24:27]
  v_mfma_f32_16x16x32_bf16 v[28:31], v[100:103], a[92:95], v[28:31]
  s_waitcnt vmcnt(17) lgkmcnt(8)
  v_mfma_f32_16x16x32_bf16 v[16:19], v[104:107], a[96:99], v[16:19]
  buffer_load_dwordx4 v[100:103], v3, s[8:11], s45 offen offset:1024
  v_mfma_f32_16x16x32_bf16 v[20:23], v[104:107], a[100:103], v[20:23]
  ds_read_b128 a[144:147], v7 offset:36864
  ds_read_b128 a[148:151], v7 offset:37888
  ds_read_b128 a[152:155], v7 offset:38912
  ds_read_b128 a[156:159], v7 offset:39936
  v_mfma_f32_16x16x32_bf16 v[24:27], v[104:107], a[104:107], v[24:27]
  v_mfma_f32_16x16x32_bf16 v[28:31], v[104:107], a[108:111], v[28:31]
  s_waitcnt vmcnt(17) lgkmcnt(8)
  v_mfma_f32_16x16x32_bf16 v[16:19], v[108:111], a[112:115], v[16:19]
  buffer_load_dwordx4 v[104:107], v3, s[8:11], s45 offen offset:2048
  v_mfma_f32_16x16x32_bf16 v[20:23], v[108:111], a[116:119], v[20:23]
  ds_read_b128 a[160:163], v7 offset:40960
  ds_read_b128 a[164:167], v7 offset:41984
  ds_read_b128 a[168:171], v7 offset:43008
  ds_read_b128 a[172:175], v7 offset:44032
  v_mfma_f32_16x16x32_bf16 v[24:27], v[108:111], a[120:123], v[24:27]
  v_mfma_f32_16x16x32_bf16 v[28:31], v[108:111], a[124:127], v[28:31]
  s_waitcnt vmcnt(17) lgkmcnt(8)
  v_mfma_f32_16x16x32_bf16 v[16:19], v[112:115], a[128:131], v[16:19]
  buffer_load_dwordx4 v[108:111], v3, s[8:11], s45 offen offset:3072
  v_mfma_f32_16x16x32_bf16 v[20:23], v[112:115], a[132:135], v[20:23]
  ds_read_b128 a[176:179], v7 offset:45056
  ds_read_b128 a[180:183], v7 offset:46080
  ds_read_b128 a[184:187], v7 offset:47104
  ds_read_b128 a[188:191], v7 offset:48128
  v_mfma_f32_16x16x32_bf16 v[24:27], v[112:115], a[136:139], v[24:27]
  v_mfma_f32_16x16x32_bf16 v[28:31], v[112:115], a[140:143], v[28:31]
  s_waitcnt vmcnt(17) lgkmcnt(8)
  v_mfma_f32_16x16x32_bf16 v[16:19], v[116:119], a[144:147], v[16:19]
  buffer_load_dwordx4 v[112:115], v4, s[8:11], s45 offen offset:0
  v_mfma_f32_16x16x32_bf16 v[20:23], v[116:119], a[148:151], v[20:23]
  ds_read_b128 a[192:195], v7 offset:49152
  ds_read_b128 a[196:199], v7 offset:50176
  ds_read_b128 a[200:203], v7 offset:51200
  ds_read_b128 a[204:207], v7 offset:52224
  v_mfma_f32_16x16x32_bf16 v[24:27], v[116:119], a[152:155], v[24:27]
  v_mfma_f32_16x16x32_bf16 v[28:31], v[116:119], a[156:159], v[28:31]
  s_waitcnt vmcnt(17) lgkmcnt(8)
  v_mfma_f32_16x16x32_bf16 v[16:19], v[120:123], a[160:163], v[16:19]
  buffer_load_dwordx4 v[116:119], v4, s[8:11], s45 offen offset:1024
  v_mfma_f32_16x16x32_bf16 v[20:23], v[120:123], a[164:167], v[20:23]
  ds_read_b128 a[208:211], v7 offset:53248
  ds_read_b128 a[212:215], v7 offset:54272
  ds_read_b128 a[216:219], v7 offset:55296
  ds_read_b128 a[220:223], v7 offset:56320
  v_mfma_f32_16x16x32_bf16 v[24:27], v[120:123], a[168:171], v[24:27]
  v_mfma_f32_16x16x32_bf16 v[28:31], v[120:123], a[172:175], v[28:31]
  s_waitcnt vmcnt(17) lgkmcnt(8)
  v_mfma_f32_16x16x32_bf16 v[16:19], v[124:127], a[176:179], v[16:19]
  buffer_load_dwordx4 v[120:123], v4, s[8:11], s45 offen offset:2048
  v_mfma_f32_16x16x32_bf16 v[20:23], v[124:127], a[180:183], v[20:23]
  ds_read_b128 a[224:227], v7 offset:57344
  ds_read_b128 a[228:231], v7 offset:58368
  ds_read_b128 a[232:235], v7 offset:59392
  ds_read_b128 a[236:239], v7 offset:60416
  v_mfma_f32_16x16x32_bf16 v[24:27], v[124:127], a[184:187], v[24:27]
  v_mfma_f32_16x16x32_bf16 v[28:31], v[124:127], a[188:191], v[28:31]
  s_waitcnt vmcnt(17) lgkmcnt(8)
  v_mfma_f32_16x16x32_bf16 v[16:19], v[128:131], a[192:195], v[16:19]
  buffer_load_dwordx4 v[124:127], v4, s[8:11], s45 offen offset:3072
  v_mfma_f32_16x16x32_bf16 v[20:23], v[128:131], a[196:199], v[20:23]
  ds_read_b128 a[240:243], v7 offset:61440
  ds_read_b128 a[244:247], v7 offset:62464
  ds_read_b128 a[248:251], v7 offset:63488
  ds_read_b128 a[252:255], v7 offset:64512
  v_mfma_f32_16x16x32_bf16 v[24:27], v[128:131], a[200:203], v[24:27]
  v_mfma_f32_16x16x32_bf16 v[28:31], v[128:131], a[204:207], v[28:31]
  s_waitcnt vmcnt(17) lgkmcnt(8)
  v_mfma_f32_16x16x32_bf16 v[16:19], v[132:135], a[208:211], v[16:19]
  buffer_load_dwordx4 v[128:131], v5, s[8:11], s45 offen offset:0
  v_mfma_f32_16x16x32_bf16 v[20:23], v[132:135], a[212:215], v[20:23]
  ds_read_b128 v[224:227], v8 offset:0
  ds_read_b128 v[228:231], v8 offset:1024
  ds_read_b128 v[232:235], v8 offset:2048
  ds_read_b128 v[236:239], v8 offset:3072
  v_mfma_f32_16x16x32_bf16 v[24:27], v[132:135], a[216:219], v[24:27]
  v_mfma_f32_16x16x32_bf16 v[28:31], v[132:135], a[220:223], v[28:31]
  s_waitcnt vmcnt(17) lgkmcnt(8)
  v_mfma_f32_16x16x32_bf16 v[16:19], v[136:139], a[224:227], v[16:19]
  buffer_load_dwordx4 v[132:135], v5, s[8:11], s45 offen offset:1024
  v_mfma_f32_16x16x32_bf16 v[20:23], v[136:139], a[228:231], v[20:23]
  ds_read_b128 v[240:243], v8 offset:4096
  ds_read_b128 v[244:247], v8 offset:5120
  ds_read_b128 v[248:251], v8 offset:6144
  ds_read_b128 v[252:255], v8 offset:7168
  v_mfma_f32_16x16x32_bf16 v[24:27], v[136:139], a[232:235], v[24:27]
  v_mfma_f32_16x16x32_bf16 v[28:31], v[136:139], a[236:239], v[28:31]
  s_waitcnt vmcnt(17) lgkmcnt(8)
  v_mfma_f32_16x16x32_bf16 v[16:19], v[140:143], a[240:243], v[16:19]
  buffer_load_dwordx4 v[136:139], v5, s[8:11], s45 offen offset:2048
  v_mfma_f32_16x16x32_bf16 v[20:23], v[140:143], a[244:247], v[20:23]
  v_mfma_f32_16x16x32_bf16 v[24:27], v[140:143], a[248:251], v[24:27]
  v_mfma_f32_16x16x32_bf16 v[28:31], v[140:143], a[252:255], v[28:31]
  s_waitcnt vmcnt(17) lgkmcnt(4)
  v_mfma_f32_16x16x32_bf16 v[16:19], v[144:147], v[224:227], v[16:19]
  buffer_load_dwordx4 v[140:143], v5, s[8:11], s45 offen offset:3072
  v_mfma_f32_16x16x32_bf16 v[20:23], v[144:147], v[228:231], v[20:23]
  v_mfma_f32_16x16x32_bf16 v[24:27], v[144:147], v[232:235], v[24:27]
  v_mfma_f32_16x16x32_bf16 v[28:31], v[144:147], v[236:239], v[28:31]
  s_waitcnt vmcnt(17) lgkmcnt(0)
  v_mfma_f32_16x16x32_bf16 v[16:19], v[148:151], v[240:243], v[16:19]
  buffer_load_dwordx4 v[144:147], v6, s[8:11], s45 offen offset:0
  v_mfma_f32_16x16x32_bf16 v[20:23], v[148:151], v[244:247], v[20:23]
  v_mfma_f32_16x16x32_bf16 v[24:27], v[148:151], v[248:251], v[24:27]
  v_mfma_f32_16x16x32_bf16 v[28:31], v[148:151], v[252:255], v[28:31]
  s_barrier
  s_mov_b32 s43, 1
ffn_kernel_p1loop:
  s_lshl_b32 s50, s49, 13
  v_add_u32 v9, s50, v14
  s_mov_b32 s49, s59
  s_mov_b32 s44, s45
  s_add_u32 s59, s49, 1
  s_cmp_eq_u32 s59, 9
  s_cselect_b32 s59, 0, s59
  s_cmp_eq_u32 s43, 8
  s_cselect_b32 s51, s48, s58
  s_mul_i32 s50, s59, 73728
  s_add_u32 s45, s51, s50
  s_lshl_b32 s50, s59, 7
  s_add_u32 s47, s61, s50
  s_add_u32 s43, s43, 1
  s_waitcnt vmcnt(16)
  v_lshlrev_b32 v72, 16, v76
  v_and_b32 v73, s63, v76
  v_lshlrev_b32 v74, 16, v77
  v_and_b32 v75, s63, v77
  s_nop 1
  v_mfma_f32_16x16x32_bf16 v[32:35], v[80:83], a[0:3], v[72:75]
  buffer_load_dwordx4 v[148:151], v6, s[8:11], s44 offen offset:1024
  v_mfma_f32_16x16x32_bf16 v[36:39], v[80:83], a[4:7], v[72:75]
  v_mfma_f32_16x16x32_bf16 v[40:43], v[80:83], a[8:11], v[72:75]
  v_mfma_f32_16x16x32_bf16 v[44:47], v[80:83], a[12:15], v[72:75]
  s_waitcnt vmcnt(16)
  v_mfma_f32_16x16x32_bf16 v[32:35], v[84:87], a[16:19], v[32:35]
  buffer_load_dwordx2 v[76:77], v11, s[12:15], s47 offen
  buffer_load_dwordx4 v[80:83], v2, s[8:11], s45 offen offset:0
  v_mul_f32 v48, v16, v16
  v_mfma_f32_16x16x32_bf16 v[36:39], v[84:87], a[20:23], v[36:39]
  v_mul_f32 v49, v17, v17
  v_mul_f32 v50, v18, v18
  v_mfma_f32_16x16x32_bf16 v[40:43], v[84:87], a[24:27], v[40:43]
  v_mul_f32 v51, v19, v19
  v_fma_f32 v48, v48, v13, v12
  v_mfma_f32_16x16x32_bf16 v[44:47], v[84:87], a[28:31], v[44:47]
  v_fma_f32 v49, v49, v13, v12
  v_fma_f32 v50, v50, v13, v12
  s_waitcnt vmcnt(17)
  v_mfma_f32_16x16x32_bf16 v[32:35], v[88:91], a[32:35], v[32:35]
  buffer_load_dwordx4 v[84:87], v2, s[8:11], s45 offen offset:1024
  v_fma_f32 v51, v51, v13, v12
  v_mul_f32 v48, v48, v16
  v_mfma_f32_16x16x32_bf16 v[36:39], v[88:91], a[36:39], v[36:39]
  v_mul_f32 v49, v49, v17
  v_mul_f32 v50, v50, v18
  v_mfma_f32_16x16x32_bf16 v[40:43], v[88:91], a[40:43], v[40:43]
  v_mul_f32 v51, v51, v19
  v_exp_f32 v48, v48
  v_mfma_f32_16x16x32_bf16 v[44:47], v[88:91], a[44:47], v[44:47]
  v_exp_f32 v49, v49
  v_exp_f32 v50, v50
  s_waitcnt vmcnt(17)
  v_mfma_f32_16x16x32_bf16 v[32:35], v[92:95], a[48:51], v[32:35]
  buffer_load_dwordx4 v[88:91], v2, s[8:11], s45 offen offset:2048
  v_exp_f32 v51, v51
  v_add_f32 v48, 1.0, v48
  v_mfma_f32_16x16x32_bf16 v[36:39], v[92:95], a[52:55], v[36:39]
  v_add_f32 v49, 1.0, v49
  v_add_f32 v50, 1.0, v50
  v_mfma_f32_16x16x32_bf16 v[40:43], v[92:95], a[56:59], v[40:43]
  v_add_f32 v51, 1.0, v51
  v_rcp_f32 v48, v48
  v_mfma_f32_16x16x32_bf16 v[44:47], v[92:95], a[60:63], v[44:47]
  v_rcp_f32 v49, v49
  v_rcp_f32 v50, v50
  s_waitcnt vmcnt(17)
  v_mfma_f32_16x16x32_bf16 v[32:35], v[96:99], a[64:67], v[32:35]
  buffer_load_dwordx4 v[92:95], v2, s[8:11], s45 offen offset:3072
  v_rcp_f32 v51, v51
  v_mul_f32 v48, v16, v48
  v_mfma_f32_16x16x32_bf16 v[36:39], v[96:99], a[68:71], v[36:39]
  v_mul_f32 v49, v17, v49
  v_mul_f32 v50, v18, v50
  v_mfma_f32_16x16x32_bf16 v[40:43], v[96:99], a[72:75], v[40:43]
  v_mul_f32 v51, v19, v51
  v_cvt_pk_bf16_f32 v64, v48, v49
  v_mfma_f32_16x16x32_bf16 v[44:47], v[96:99], a[76:79], v[44:47]
  v_cvt_pk_bf16_f32 v65, v50, v51
  ds_write_b64 v9, v[64:65] offset:0
  s_waitcnt vmcnt(17)
  v_mfma_f32_16x16x32_bf16 v[32:35], v[100:103], a[80:83], v[32:35]
  buffer_load_dwordx4 v[96:99], v3, s[8:11], s45 offen offset:0
  v_mul_f32 v52, v20, v20
  v_mfma_f32_16x16x32_bf16 v[36:39], v[100:103], a[84:87], v[36:39]
  v_mul_f32 v53, v21, v21
  v_mul_f32 v54, v22, v22
  v_mfma_f32_16x16x32_bf16 v[40:43], v[100:103], a[88:91], v[40:43]
  v_mul_f32 v55, v23, v23
  v_fma_f32 v52, v52, v13, v12
  v_mfma_f32_16x16x32_bf16 v[44:47], v[100:103], a[92:95], v[44:47]
  v_fma_f32 v53, v53, v13, v12
  v_fma_f32 v54, v54, v13, v12
  s_waitcnt vmcnt(17)
  v_mfma_f32_16x16x32_bf16 v[32:35], v[104:107], a[96:99], v[32:35]
  buffer_load_dwordx4 v[100:103], v3, s[8:11], s45 offen offset:1024
  v_fma_f32 v55, v55, v13, v12
  v_mul_f32 v52, v52, v20
  v_mfma_f32_16x16x32_bf16 v[36:39], v[104:107], a[100:103], v[36:39]
  v_mul_f32 v53, v53, v21
  v_mul_f32 v54, v54, v22
  v_mfma_f32_16x16x32_bf16 v[40:43], v[104:107], a[104:107], v[40:43]
  v_mul_f32 v55, v55, v23
  v_exp_f32 v52, v52
  v_mfma_f32_16x16x32_bf16 v[44:47], v[104:107], a[108:111], v[44:47]
  v_exp_f32 v53, v53
  v_exp_f32 v54, v54
  s_waitcnt vmcnt(17)
  v_mfma_f32_16x16x32_bf16 v[32:35], v[108:111], a[112:115], v[32:35]
  buffer_load_dwordx4 v[104:107], v3, s[8:11], s45 offen offset:2048
  v_exp_f32 v55, v55
  v_add_f32 v52, 1.0, v52
  v_mfma_f32_16x16x32_bf16 v[36:39], v[108:111], a[116:119], v[36:39]
  v_add_f32 v53, 1.0, v53
  v_add_f32 v54, 1.0, v54
  v_mfma_f32_16x16x32_bf16 v[40:43], v[108:111], a[120:123], v[40:43]
  v_add_f32 v55, 1.0, v55
  v_rcp_f32 v52, v52
  v_mfma_f32_16x16x32_bf16 v[44:47], v[108:111], a[124:127], v[44:47]
  v_rcp_f32 v53, v53
  v_rcp_f32 v54, v54
  s_waitcnt vmcnt(17)
  v_mfma_f32_16x16x32_bf16 v[32:35], v[112:115], a[128:131], v[32:35]
  buffer_load_dwordx4 v[108:111], v3, s[8:11], s45 offen offset:3072
  v_rcp_f32 v55, v55
  v_mul_f32 v52, v20, v52
  v_mfma_f32_16x16x32_bf16 v[36:39], v[112:115], a[132:135], v[36:39]
  v_mul_f32 v53, v21, v53
  v_mul_f32 v54, v22, v54
  v_mfma_f32_16x16x32_bf16 v[40:43], v[112:115], a[136:139], v[40:43]
  v_mul_f32 v55, v23, v55
  v_cvt_pk_bf16_f32 v66, v52, v53
  v_mfma_f32_16x16x32_bf16 v[44:47], v[112:115], a[140:143], v[44:47]
  v_cvt_pk_bf16_f32 v67, v54, v55
  ds_write_b64 v9, v[66:67] offset:1024
  s_waitcnt vmcnt(17)
  v_mfma_f32_16x16x32_bf16 v[32:35], v[116:119], a[144:147], v[32:35]
  buffer_load_dwordx4 v[112:115], v4, s[8:11], s45 offen offset:0
  v_mul_f32 v56, v24, v24
  v_mfma_f32_16x16x32_bf16 v[36:39], v[116:119], a[148:151], v[36:39]
  v_mul_f32 v57, v25, v25
  v_mul_f32 v58, v26, v26
  v_mfma_f32_16x16x32_bf16 v[40:43], v[116:119], a[152:155], v[40:43]
  v_mul_f32 v59, v27, v27
  v_fma_f32 v56, v56, v13, v12
  v_mfma_f32_16x16x32_bf16 v[44:47], v[116:119], a[156:159], v[44:47]
  v_fma_f32 v57, v57, v13, v12
  v_fma_f32 v58, v58, v13, v12
  s_waitcnt vmcnt(17)
  v_mfma_f32_16x16x32_bf16 v[32:35], v[120:123], a[160:163], v[32:35]
  buffer_load_dwordx4 v[116:119], v4, s[8:11], s45 offen offset:1024
  v_fma_f32 v59, v59, v13, v12
  v_mul_f32 v56, v56, v24
  v_mfma_f32_16x16x32_bf16 v[36:39], v[120:123], a[164:167], v[36:39]
  v_mul_f32 v57, v57, v25
  v_mul_f32 v58, v58, v26
  v_mfma_f32_16x16x32_bf16 v[40:43], v[120:123], a[168:171], v[40:43]
  v_mul_f32 v59, v59, v27
  v_exp_f32 v56, v56
  v_mfma_f32_16x16x32_bf16 v[44:47], v[120:123], a[172:175], v[44:47]
  v_exp_f32 v57, v57
  v_exp_f32 v58, v58
  s_waitcnt vmcnt(17)
  v_mfma_f32_16x16x32_bf16 v[32:35], v[124:127], a[176:179], v[32:35]
  buffer_load_dwordx4 v[120:123], v4, s[8:11], s45 offen offset:2048
  v_exp_f32 v59, v59
  v_add_f32 v56, 1.0, v56
  v_mfma_f32_16x16x32_bf16 v[36:39], v[124:127], a[180:183], v[36:39]
  v_add_f32 v57, 1.0, v57
  v_add_f32 v58, 1.0, v58
  v_mfma_f32_16x16x32_bf16 v[40:43], v[124:127], a[184:187], v[40:43]
  v_add_f32 v59, 1.0, v59
  v_rcp_f32 v56, v56
  v_mfma_f32_16x16x32_bf16 v[44:47], v[124:127], a[188:191], v[44:47]
  v_rcp_f32 v57, v57
  v_rcp_f32 v58, v58
  s_waitcnt vmcnt(17)
  v_mfma_f32_16x16x32_bf16 v[32:35], v[128:131], a[192:195], v[32:35]
  buffer_load_dwordx4 v[124:127], v4, s[8:11], s45 offen offset:3072
  v_rcp_f32 v59, v59
  v_mul_f32 v56, v24, v56
  v_mfma_f32_16x16x32_bf16 v[36:39], v[128:131], a[196:199], v[36:39]
  v_mul_f32 v57, v25, v57
  v_mul_f32 v58, v26, v58
  v_mfma_f32_16x16x32_bf16 v[40:43], v[128:131], a[200:203], v[40:43]
  v_mul_f32 v59, v27, v59
  v_cvt_pk_bf16_f32 v68, v56, v57
  v_mfma_f32_16x16x32_bf16 v[44:47], v[128:131], a[204:207], v[44:47]
  v_cvt_pk_bf16_f32 v69, v58, v59
  ds_write_b64 v9, v[68:69] offset:2048
  s_waitcnt vmcnt(17)
  v_mfma_f32_16x16x32_bf16 v[32:35], v[132:135], a[208:211], v[32:35]
  buffer_load_dwordx4 v[128:131], v5, s[8:11], s45 offen offset:0
  v_mul_f32 v60, v28, v28
  v_mfma_f32_16x16x32_bf16 v[36:39], v[132:135], a[212:215], v[36:39]
  v_mul_f32 v61, v29, v29
  v_mul_f32 v62, v30, v30
  v_mfma_f32_16x16x32_bf16 v[40:43], v[132:135], a[216:219], v[40:43]
  v_mul_f32 v63, v31, v31
  v_fma_f32 v60, v60, v13, v12
  v_mfma_f32_16x16x32_bf16 v[44:47], v[132:135], a[220:223], v[44:47]
  v_fma_f32 v61, v61, v13, v12
  v_fma_f32 v62, v62, v13, v12
  s_waitcnt vmcnt(17)
  v_mfma_f32_16x16x32_bf16 v[32:35], v[136:139], a[224:227], v[32:35]
  buffer_load_dwordx4 v[132:135], v5, s[8:11], s45 offen offset:1024
  v_fma_f32 v63, v63, v13, v12
  v_mul_f32 v60, v60, v28
  v_mfma_f32_16x16x32_bf16 v[36:39], v[136:139], a[228:231], v[36:39]
  v_mul_f32 v61, v61, v29
  v_mul_f32 v62, v62, v30
  v_mfma_f32_16x16x32_bf16 v[40:43], v[136:139], a[232:235], v[40:43]
  v_mul_f32 v63, v63, v31
  v_exp_f32 v60, v60
  v_mfma_f32_16x16x32_bf16 v[44:47], v[136:139], a[236:239], v[44:47]
  v_exp_f32 v61, v61
  v_exp_f32 v62, v62
  s_waitcnt vmcnt(17)
  v_mfma_f32_16x16x32_bf16 v[32:35], v[140:143], a[240:243], v[32:35]
  buffer_load_dwordx4 v[136:139], v5, s[8:11], s45 offen offset:2048
  v_exp_f32 v63, v63
  v_add_f32 v60, 1.0, v60
  v_mfma_f32_16x16x32_bf16 v[36:39], v[140:143], a[244:247], v[36:39]
  v_add_f32 v61, 1.0, v61
  v_add_f32 v62, 1.0, v62
  v_mfma_f32_16x16x32_bf16 v[40:43], v[140:143], a[248:251], v[40:43]
  v_add_f32 v63, 1.0, v63
  v_rcp_f32 v60, v60
  v_mfma_f32_16x16x32_bf16 v[44:47], v[140:143], a[252:255], v[44:47]
  v_rcp_f32 v61, v61
  v_rcp_f32 v62, v62
  s_waitcnt vmcnt(17)
  v_mfma_f32_16x16x32_bf16 v[32:35], v[144:147], v[224:227], v[32:35]
  buffer_load_dwordx4 v[140:143], v5, s[8:11], s45 offen offset:3072
  v_rcp_f32 v63, v63
  v_mul_f32 v60, v28, v60
  v_mfma_f32_16x16x32_bf16 v[36:39], v[144:147], v[228:231], v[36:39]
  v_mul_f32 v61, v29, v61
  v_mul_f32 v62, v30, v62
  v_mfma_f32_16x16x32_bf16 v[40:43], v[144:147], v[232:235], v[40:43]
  v_mul_f32 v63, v31, v63
  v_cvt_pk_bf16_f32 v70, v60, v61
  v_mfma_f32_16x16x32_bf16 v[44:47], v[144:147], v[236:239], v[44:47]
  v_cvt_pk_bf16_f32 v71, v62, v63
  ds_write_b64 v9, v[70:71] offset:3072
  s_waitcnt vmcnt(17)
  v_mfma_f32_16x16x32_bf16 v[32:35], v[148:151], v[240:243], v[32:35]
  buffer_load_dwordx4 v[144:147], v6, s[8:11], s45 offen offset:0
  v_mfma_f32_16x16x32_bf16 v[36:39], v[148:151], v[244:247], v[36:39]
  v_mfma_f32_16x16x32_bf16 v[40:43], v[148:151], v[248:251], v[40:43]
  v_mfma_f32_16x16x32_bf16 v[44:47], v[148:151], v[252:255], v[44:47]
  s_lshl_b32 s50, s49, 13
  v_add_u32 v9, s50, v14
  s_mov_b32 s49, s59
  s_mov_b32 s44, s45
  s_add_u32 s59, s49, 1
  s_cmp_eq_u32 s59, 9
  s_cselect_b32 s59, 0, s59
  s_cmp_eq_u32 s43, 8
  s_cselect_b32 s51, s48, s58
  s_mul_i32 s50, s59, 73728
  s_add_u32 s45, s51, s50
  s_lshl_b32 s50, s59, 7
  s_add_u32 s47, s61, s50
  s_add_u32 s43, s43, 1
  s_waitcnt vmcnt(16)
  v_lshlrev_b32 v72, 16, v76
  v_and_b32 v73, s63, v76
  v_lshlrev_b32 v74, 16, v77
  v_and_b32 v75, s63, v77
  s_nop 1
  v_mfma_f32_16x16x32_bf16 v[16:19], v[80:83], a[0:3], v[72:75]
  buffer_load_dwordx4 v[148:151], v6, s[8:11], s44 offen offset:1024
  v_mfma_f32_16x16x32_bf16 v[20:23], v[80:83], a[4:7], v[72:75]
  v_mfma_f32_16x16x32_bf16 v[24:27], v[80:83], a[8:11], v[72:75]
  v_mfma_f32_16x16x32_bf16 v[28:31], v[80:83], a[12:15], v[72:75]
  s_waitcnt vmcnt(16)
  v_mfma_f32_16x16x32_bf16 v[16:19], v[84:87], a[16:19], v[16:19]
  buffer_load_dwordx2 v[76:77], v11, s[12:15], s47 offen
  buffer_load_dwordx4 v[80:83], v2, s[8:11], s45 offen offset:0
  v_mul_f32 v48, v32, v32
  v_mfma_f32_16x16x32_bf16 v[20:23], v[84:87], a[20:23], v[20:23]
  v_mul_f32 v49, v33, v33
  v_mul_f32 v50, v34, v34
  v_mfma_f32_16x16x32_bf16 v[24:27], v[84:87], a[24:27], v[24:27]
  v_mul_f32 v51, v35, v35
  v_fma_f32 v48, v48, v13, v12
  v_mfma_f32_16x16x32_bf16 v[28:31], v[84:87], a[28:31], v[28:31]
  v_fma_f32 v49, v49, v13, v12
  v_fma_f32 v50, v50, v13, v12
  s_waitcnt vmcnt(17)
  v_mfma_f32_16x16x32_bf16 v[16:19], v[88:91], a[32:35], v[16:19]
  buffer_load_dwordx4 v[84:87], v2, s[8:11], s45 offen offset:1024
  v_fma_f32 v51, v51, v13, v12
  v_mul_f32 v48, v48, v32
  v_mfma_f32_16x16x32_bf16 v[20:23], v[88:91], a[36:39], v[20:23]
  v_mul_f32 v49, v49, v33
  v_mul_f32 v50, v50, v34
  v_mfma_f32_16x16x32_bf16 v[24:27], v[88:91], a[40:43], v[24:27]
  v_mul_f32 v51, v51, v35
  v_exp_f32 v48, v48
  v_mfma_f32_16x16x32_bf16 v[28:31], v[88:91], a[44:47], v[28:31]
  v_exp_f32 v49, v49
  v_exp_f32 v50, v50
  s_waitcnt vmcnt(17)
  v_mfma_f32_16x16x32_bf16 v[16:19], v[92:95], a[48:51], v[16:19]
  buffer_load_dwordx4 v[88:91], v2, s[8:11], s45 offen offset:2048
  v_exp_f32 v51, v51
  v_add_f32 v48, 1.0, v48
  v_mfma_f32_16x16x32_bf16 v[20:23], v[92:95], a[52:55], v[20:23]
  v_add_f32 v49, 1.0, v49
  v_add_f32 v50, 1.0, v50
  v_mfma_f32_16x16x32_bf16 v[24:27], v[92:95], a[56:59], v[24:27]
  v_add_f32 v51, 1.0, v51
  v_rcp_f32 v48, v48
  v_mfma_f32_16x16x32_bf16 v[28:31], v[92:95], a[60:63], v[28:31]
  v_rcp_f32 v49, v49
  v_rcp_f32 v50, v50
  s_waitcnt vmcnt(17)
  v_mfma_f32_16x16x32_bf16 v[16:19], v[96:99], a[64:67], v[16:19]
  buffer_load_dwordx4 v[92:95], v2, s[8:11], s45 offen offset:3072
  v_rcp_f32 v51, v51
  v_mul_f32 v48, v32, v48
  v_mfma_f32_16x16x32_bf16 v[20:23], v[96:99], a[68:71], v[20:23]
  v_mul_f32 v49, v33, v49
  v_mul_f32 v50, v34, v50
  v_mfma_f32_16x16x32_bf16 v[24:27], v[96:99], a[72:75], v[24:27]
  v_mul_f32 v51, v35, v51
  v_cvt_pk_bf16_f32 v64, v48, v49
  v_mfma_f32_16x16x32_bf16 v[28:31], v[96:99], a[76:79], v[28:31]
  v_cvt_pk_bf16_f32 v65, v50, v51
  ds_write_b64 v9, v[64:65] offset:0
  s_waitcnt vmcnt(17)
  v_mfma_f32_16x16x32_bf16 v[16:19], v[100:103], a[80:83], v[16:19]
  buffer_load_dwordx4 v[96:99], v3, s[8:11], s45 offen offset:0
  v_mul_f32 v52, v36, v36
  v_mfma_f32_16x16x32_bf16 v[20:23], v[100:103], a[84:87], v[20:23]
  v_mul_f32 v53, v37, v37
  v_mul_f32 v54, v38, v38
  v_mfma_f32_16x16x32_bf16 v[24:27], v[100:103], a[88:91], v[24:27]
  v_mul_f32 v55, v39, v39
  v_fma_f32 v52, v52, v13, v12
  v_mfma_f32_16x16x32_bf16 v[28:31], v[100:103], a[92:95], v[28:31]
  v_fma_f32 v53, v53, v13, v12
  v_fma_f32 v54, v54, v13, v12
  s_waitcnt vmcnt(17)
  v_mfma_f32_16x16x32_bf16 v[16:19], v[104:107], a[96:99], v[16:19]
  buffer_load_dwordx4 v[100:103], v3, s[8:11], s45 offen offset:1024
  v_fma_f32 v55, v55, v13, v12
  v_mul_f32 v52, v52, v36
  v_mfma_f32_16x16x32_bf16 v[20:23], v[104:107], a[100:103], v[20:23]
  v_mul_f32 v53, v53, v37
  v_mul_f32 v54, v54, v38
  v_mfma_f32_16x16x32_bf16 v[24:27], v[104:107], a[104:107], v[24:27]
  v_mul_f32 v55, v55, v39
  v_exp_f32 v52, v52
  v_mfma_f32_16x16x32_bf16 v[28:31], v[104:107], a[108:111], v[28:31]
  v_exp_f32 v53, v53
  v_exp_f32 v54, v54
  s_waitcnt vmcnt(17)
  v_mfma_f32_16x16x32_bf16 v[16:19], v[108:111], a[112:115], v[16:19]
  buffer_load_dwordx4 v[104:107], v3, s[8:11], s45 offen offset:2048
  v_exp_f32 v55, v55
  v_add_f32 v52, 1.0, v52
  v_mfma_f32_16x16x32_bf16 v[20:23], v[108:111], a[116:119], v[20:23]
  v_add_f32 v53, 1.0, v53
  v_add_f32 v54, 1.0, v54
  v_mfma_f32_16x16x32_bf16 v[24:27], v[108:111], a[120:123], v[24:27]
  v_add_f32 v55, 1.0, v55
  v_rcp_f32 v52, v52
  v_mfma_f32_16x16x32_bf16 v[28:31], v[108:111], a[124:127], v[28:31]
  v_rcp_f32 v53, v53
  v_rcp_f32 v54, v54
  s_waitcnt vmcnt(17)
  v_mfma_f32_16x16x32_bf16 v[16:19], v[112:115], a[128:131], v[16:19]
  buffer_load_dwordx4 v[108:111], v3, s[8:11], s45 offen offset:3072
  v_rcp_f32 v55, v55
  v_mul_f32 v52, v36, v52
  v_mfma_f32_16x16x32_bf16 v[20:23], v[112:115], a[132:135], v[20:23]
  v_mul_f32 v53, v37, v53
  v_mul_f32 v54, v38, v54
  v_mfma_f32_16x16x32_bf16 v[24:27], v[112:115], a[136:139], v[24:27]
  v_mul_f32 v55, v39, v55
  v_cvt_pk_bf16_f32 v66, v52, v53
  v_mfma_f32_16x16x32_bf16 v[28:31], v[112:115], a[140:143], v[28:31]
  v_cvt_pk_bf16_f32 v67, v54, v55
  ds_write_b64 v9, v[66:67] offset:1024
  s_waitcnt vmcnt(17)
  v_mfma_f32_16x16x32_bf16 v[16:19], v[116:119], a[144:147], v[16:19]
  buffer_load_dwordx4 v[112:115], v4, s[8:11], s45 offen offset:0
  v_mul_f32 v56, v40, v40
  v_mfma_f32_16x16x32_bf16 v[20:23], v[116:119], a[148:151], v[20:23]
  v_mul_f32 v57, v41, v41
  v_mul_f32 v58, v42, v42
  v_mfma_f32_16x16x32_bf16 v[24:27], v[116:119], a[152:155], v[24:27]
  v_mul_f32 v59, v43, v43
  v_fma_f32 v56, v56, v13, v12
  v_mfma_f32_16x16x32_bf16 v[28:31], v[116:119], a[156:159], v[28:31]
  v_fma_f32 v57, v57, v13, v12
  v_fma_f32 v58, v58, v13, v12
  s_waitcnt vmcnt(17)
  v_mfma_f32_16x16x32_bf16 v[16:19], v[120:123], a[160:163], v[16:19]
  buffer_load_dwordx4 v[116:119], v4, s[8:11], s45 offen offset:1024
  v_fma_f32 v59, v59, v13, v12
  v_mul_f32 v56, v56, v40
  v_mfma_f32_16x16x32_bf16 v[20:23], v[120:123], a[164:167], v[20:23]
  v_mul_f32 v57, v57, v41
  v_mul_f32 v58, v58, v42
  v_mfma_f32_16x16x32_bf16 v[24:27], v[120:123], a[168:171], v[24:27]
  v_mul_f32 v59, v59, v43
  v_exp_f32 v56, v56
  v_mfma_f32_16x16x32_bf16 v[28:31], v[120:123], a[172:175], v[28:31]
  v_exp_f32 v57, v57
  v_exp_f32 v58, v58
  s_waitcnt vmcnt(17)
  v_mfma_f32_16x16x32_bf16 v[16:19], v[124:127], a[176:179], v[16:19]
  buffer_load_dwordx4 v[120:123], v4, s[8:11], s45 offen offset:2048
  v_exp_f32 v59, v59
  v_add_f32 v56, 1.0, v56
  v_mfma_f32_16x16x32_bf16 v[20:23], v[124:127], a[180:183], v[20:23]
  v_add_f32 v57, 1.0, v57
  v_add_f32 v58, 1.0, v58
  v_mfma_f32_16x16x32_bf16 v[24:27], v[124:127], a[184:187], v[24:27]
  v_add_f32 v59, 1.0, v59
  v_rcp_f32 v56, v56
  v_mfma_f32_16x16x32_bf16 v[28:31], v[124:127], a[188:191], v[28:31]
  v_rcp_f32 v57, v57
  v_rcp_f32 v58, v58
  s_waitcnt vmcnt(17)
  v_mfma_f32_16x16x32_bf16 v[16:19], v[128:131], a[192:195], v[16:19]
  buffer_load_dwordx4 v[124:127], v4, s[8:11], s45 offen offset:3072
  v_rcp_f32 v59, v59
  v_mul_f32 v56, v40, v56
  v_mfma_f32_16x16x32_bf16 v[20:23], v[128:131], a[196:199], v[20:23]
  v_mul_f32 v57, v41, v57
  v_mul_f32 v58, v42, v58
  v_mfma_f32_16x16x32_bf16 v[24:27], v[128:131], a[200:203], v[24:27]
  v_mul_f32 v59, v43, v59
  v_cvt_pk_bf16_f32 v68, v56, v57
  v_mfma_f32_16x16x32_bf16 v[28:31], v[128:131], a[204:207], v[28:31]
  v_cvt_pk_bf16_f32 v69, v58, v59
  ds_write_b64 v9, v[68:69] offset:2048
  s_waitcnt vmcnt(17)
  v_mfma_f32_16x16x32_bf16 v[16:19], v[132:135], a[208:211], v[16:19]
  buffer_load_dwordx4 v[128:131], v5, s[8:11], s45 offen offset:0
  v_mul_f32 v60, v44, v44
  v_mfma_f32_16x16x32_bf16 v[20:23], v[132:135], a[212:215], v[20:23]
  v_mul_f32 v61, v45, v45
  v_mul_f32 v62, v46, v46
  v_mfma_f32_16x16x32_bf16 v[24:27], v[132:135], a[216:219], v[24:27]
  v_mul_f32 v63, v47, v47
  v_fma_f32 v60, v60, v13, v12
  v_mfma_f32_16x16x32_bf16 v[28:31], v[132:135], a[220:223], v[28:31]
  v_fma_f32 v61, v61, v13, v12
  v_fma_f32 v62, v62, v13, v12
  s_waitcnt vmcnt(17)
  v_mfma_f32_16x16x32_bf16 v[16:19], v[136:139], a[224:227], v[16:19]
  buffer_load_dwordx4 v[132:135], v5, s[8:11], s45 offen offset:1024
  v_fma_f32 v63, v63, v13, v12
  v_mul_f32 v60, v60, v44
  v_mfma_f32_16x16x32_bf16 v[20:23], v[136:139], a[228:231], v[20:23]
  v_mul_f32 v61, v61, v45
  v_mul_f32 v62, v62, v46
  v_mfma_f32_16x16x32_bf16 v[24:27], v[136:139], a[232:235], v[24:27]
  v_mul_f32 v63, v63, v47
  v_exp_f32 v60, v60
  v_mfma_f32_16x16x32_bf16 v[28:31], v[136:139], a[236:239], v[28:31]
  v_exp_f32 v61, v61
  v_exp_f32 v62, v62
  s_waitcnt vmcnt(17)
  v_mfma_f32_16x16x32_bf16 v[16:19], v[140:143], a[240:243], v[16:19]
  buffer_load_dwordx4 v[136:139], v5, s[8:11], s45 offen offset:2048
  v_exp_f32 v63, v63
  v_add_f32 v60, 1.0, v60
  v_mfma_f32_16x16x32_bf16 v[20:23], v[140:143], a[244:247], v[20:23]
  v_add_f32 v61, 1.0, v61
  v_add_f32 v62, 1.0, v62
  v_mfma_f32_16x16x32_bf16 v[24:27], v[140:143], a[248:251], v[24:27]
  v_add_f32 v63, 1.0, v63
  v_rcp_f32 v60, v60
  v_mfma_f32_16x16x32_bf16 v[28:31], v[140:143], a[252:255], v[28:31]
  v_rcp_f32 v61, v61
  v_rcp_f32 v62, v62
  s_waitcnt vmcnt(17)
  v_mfma_f32_16x16x32_bf16 v[16:19], v[144:147], v[224:227], v[16:19]
  buffer_load_dwordx4 v[140:143], v5, s[8:11], s45 offen offset:3072
  v_rcp_f32 v63, v63
  v_mul_f32 v60, v44, v60
  v_mfma_f32_16x16x32_bf16 v[20:23], v[144:147], v[228:231], v[20:23]
  v_mul_f32 v61, v45, v61
  v_mul_f32 v62, v46, v62
  v_mfma_f32_16x16x32_bf16 v[24:27], v[144:147], v[232:235], v[24:27]
  v_mul_f32 v63, v47, v63
  v_cvt_pk_bf16_f32 v70, v60, v61
  v_mfma_f32_16x16x32_bf16 v[28:31], v[144:147], v[236:239], v[28:31]
  v_cvt_pk_bf16_f32 v71, v62, v63
  ds_write_b64 v9, v[70:71] offset:3072
  s_waitcnt vmcnt(17)
  v_mfma_f32_16x16x32_bf16 v[16:19], v[148:151], v[240:243], v[16:19]
  buffer_load_dwordx4 v[144:147], v6, s[8:11], s45 offen offset:0
  v_mfma_f32_16x16x32_bf16 v[20:23], v[148:151], v[244:247], v[20:23]
  v_mfma_f32_16x16x32_bf16 v[24:27], v[148:151], v[248:251], v[24:27]
  v_mfma_f32_16x16x32_bf16 v[28:31], v[148:151], v[252:255], v[28:31]
  s_cmp_lt_u32 s43, 9
  s_cbranch_scc1 ffn_kernel_p1loop
  s_lshl_b32 s50, s49, 13
  v_add_u32 v9, s50, v14
  s_waitcnt lgkmcnt(0)
  s_barrier
  s_mov_b32 s49, s59
  s_mov_b32 s44, s45
  s_add_u32 s59, s49, 1
  s_cmp_eq_u32 s59, 9
  s_cselect_b32 s59, 0, s59
  s_add_u32 s65, s59, 1
  s_cmp_eq_u32 s65, 9
  s_cselect_b32 s65, 0, s65
  s_mul_i32 s50, s59, 73728
  s_add_u32 s45, s48, s50
  s_mul_i32 s50, s65, 73728
  s_add_u32 s64, s48, s50
  ds_read_b128 a[0:3], v7 offset:0
  ds_read_b128 a[4:7], v7 offset:1024
  ds_read_b128 a[8:11], v7 offset:2048
  ds_read_b128 a[12:15], v7 offset:3072
  ds_read_b128 a[16:19], v7 offset:4096
  ds_read_b128 a[20:23], v7 offset:5120
  ds_read_b128 a[24:27], v7 offset:6144
  ds_read_b128 a[28:31], v7 offset:7168
  ds_read_b128 a[32:35], v7 offset:8192
  ds_read_b128 a[36:39], v7 offset:9216
  ds_read_b128 a[40:43], v7 offset:10240
  ds_read_b128 a[44:47], v7 offset:11264
  s_waitcnt vmcnt(16) lgkmcnt(8)
  v_mfma_f32_16x16x32_bf16 v[32:35], v[80:83], a[0:3], 0
  buffer_load_dwordx4 v[148:151], v6, s[8:11], s44 offen offset:1024
  v_mfma_f32_16x16x32_bf16 v[36:39], v[80:83], a[4:7], 0
  ds_read_b128 a[48:51], v7 offset:12288
  ds_read_b128 a[52:55], v7 offset:13312
  ds_read_b128 a[56:59], v7 offset:14336
  ds_read_b128 a[60:63], v7 offset:15360
  v_mfma_f32_16x16x32_bf16 v[40:43], v[80:83], a[8:11], 0
  v_mfma_f32_16x16x32_bf16 v[44:47], v[80:83], a[12:15], 0
  s_waitcnt vmcnt(16) lgkmcnt(8)
  v_mfma_f32_16x16x32_bf16 v[32:35], v[84:87], a[16:19], v[32:35]
  buffer_load_dwordx4 v[80:83], v2, s[8:11], s45 offen offset:0
  v_mul_f32 v48, v16, v16
  v_mul_f32 v49, v17, v17
  v_mfma_f32_16x16x32_bf16 v[36:39], v[84:87], a[20:23], v[36:39]
  ds_read_b128 a[64:67], v7 offset:16384
  ds_read_b128 a[68:71], v7 offset:17408
  ds_read_b128 a[72:75], v7 offset:18432
  ds_read_b128 a[76:79], v7 offset:19456
  v_mul_f32 v50, v18, v18
  v_mul_f32 v51, v19, v19
  v_fma_f32 v48, v48, v13, v12
  v_mfma_f32_16x16x32_bf16 v[40:43], v[84:87], a[24:27], v[40:43]
  v_fma_f32 v49, v49, v13, v12
  v_fma_f32 v50, v50, v13, v12
  v_fma_f32 v51, v51, v13, v12
  v_mfma_f32_16x16x32_bf16 v[44:47], v[84:87], a[28:31], v[44:47]
  v_mul_f32 v48, v48, v16
  v_mul_f32 v49, v49, v17
  v_mul_f32 v50, v50, v18
  s_waitcnt vmcnt(16) lgkmcnt(8)
  v_mfma_f32_16x16x32_bf16 v[32:35], v[88:91], a[32:35], v[32:35]
  buffer_load_dwordx4 v[84:87], v2, s[8:11], s45 offen offset:1024
  v_mul_f32 v51, v51, v19
  v_exp_f32 v48, v48
  v_exp_f32 v49, v49
  v_mfma_f32_16x16x32_bf16 v[36:39], v[88:91], a[36:39], v[36:39]
  ds_read_b128 a[80:83], v7 offset:20480
  ds_read_b128 a[84:87], v7 offset:21504
  ds_read_b128 a[88:91], v7 offset:22528
  ds_read_b128 a[92:95], v7 offset:23552
  v_exp_f32 v50, v50
  v_exp_f32 v51, v51
  v_mfma_f32_16x16x32_bf16 v[40:43], v[88:91], a[40:43], v[40:43]
  v_add_f32 v48, 1.0, v48
  v_add_f32 v49, 1.0, v49
  v_add_f32 v50, 1.0, v50
  v_mfma_f32_16x16x32_bf16 v[44:47], v[88:91], a[44:47], v[44:47]
  v_add_f32 v51, 1.0, v51
  v_rcp_f32 v48, v48
  v_rcp_f32 v49, v49
  s_waitcnt vmcnt(16) lgkmcnt(8)
  v_mfma_f32_16x16x32_bf16 v[32:35], v[92:95], a[48:51], v[32:35]
  buffer_load_dwordx4 v[88:91], v2, s[8:11], s45 offen offset:2048
  v_rcp_f32 v50, v50
  v_rcp_f32 v51, v51
  v_mul_f32 v48, v16, v48
  v_mfma_f32_16x16x32_bf16 v[36:39], v[92:95], a[52:55], v[36:39]
  ds_read_b128 a[96:99], v7 offset:24576
  ds_read_b128 a[100:103], v7 offset:25600
  ds_read_b128 a[104:107], v7 offset:26624
  ds_read_b128 a[108:111], v7 offset:27648
  v_mul_f32 v49, v17, v49
  v_mul_f32 v50, v18, v50
  v_mul_f32 v51, v19, v51
  v_mfma_f32_16x16x32_bf16 v[40:43], v[92:95], a[56:59], v[40:43]
  v_cvt_pk_bf16_f32 v64, v48, v49
  v_cvt_pk_bf16_f32 v65, v50, v51
  ds_write_b64 v9, v[64:65] offset:0
  v_mfma_f32_16x16x32_bf16 v[44:47], v[92:95], a[60:63], v[44:47]
  v_mul_f32 v52, v20, v20
  v_mul_f32 v53, v21, v21
  s_waitcnt vmcnt(16) lgkmcnt(8)
  v_mfma_f32_16x16x32_bf16 v[32:35], v[96:99], a[64:67], v[32:35]
  buffer_load_dwordx4 v[92:95], v2, s[8:11], s45 offen offset:3072
  v_mul_f32 v54, v22, v22
  v_mul_f32 v55, v23, v23
  v_fma_f32 v52, v52, v13, v12
  v_mfma_f32_16x16x32_bf16 v[36:39], v[96:99], a[68:71], v[36:39]
  ds_read_b128 a[112:115], v7 offset:28672
  ds_read_b128 a[116:119], v7 offset:29696
  ds_read_b128 a[120:123], v7 offset:30720
  ds_read_b128 a[124:127], v7 offset:31744
  v_fma_f32 v53, v53, v13, v12
  v_fma_f32 v54, v54, v13, v12
  v_fma_f32 v55, v55, v13, v12
  v_mfma_f32_16x16x32_bf16 v[40:43], v[96:99], a[72:75], v[40:43]
  v_mul_f32 v52, v52, v20
  v_mul_f32 v53, v53, v21
  v_mul_f32 v54, v54, v22
  v_mfma_f32_16x16x32_bf16 v[44:47], v[96:99], a[76:79], v[44:47]
  v_mul_f32 v55, v55, v23
  v_exp_f32 v52, v52
  v_exp_f32 v53, v53
  s_waitcnt vmcnt(16) lgkmcnt(8)
  v_mfma_f32_16x16x32_bf16 v[32:35], v[100:103], a[80:83], v[32:35]
  buffer_load_dwordx4 v[96:99], v3, s[8:11], s45 offen offset:0
  v_exp_f32 v54, v54
  v_exp_f32 v55, v55
  v_mfma_f32_16x16x32_bf16 v[36:39], v[100:103], a[84:87], v[36:39]
  ds_read_b128 a[128:131], v7 offset:32768
  ds_read_b128 a[132:135], v7 offset:33792
  ds_read_b128 a[136:139], v7 offset:34816
  ds_read_b128 a[140:143], v7 offset:35840
  v_add_f32 v52, 1.0, v52
  v_add_f32 v53, 1.0, v53
  v_add_f32 v54, 1.0, v54
  v_mfma_f32_16x16x32_bf16 v[40:43], v[100:103], a[88:91], v[40:43]
  v_add_f32 v55, 1.0, v55
  v_rcp_f32 v52, v52
  v_rcp_f32 v53, v53
  v_mfma_f32_16x16x32_bf16 v[44:47], v[100:103], a[92:95], v[44:47]
  v_rcp_f32 v54, v54
  v_rcp_f32 v55, v55
  v_mul_f32 v52, v20, v52
  s_waitcnt vmcnt(16) lgkmcnt(8)
  v_mfma_f32_16x16x32_bf16 v[32:35], v[104:107], a[96:99], v[32:35]
  buffer_load_dwordx4 v[100:103], v3, s[8:11], s45 offen offset:1024
  v_mul_f32 v53, v21, v53
  v_mul_f32 v54, v22, v54
  v_mul_f32 v55, v23, v55
  v_mfma_f32_16x16x32_bf16 v[36:39], v[104:107], a[100:103], v[36:39]
  ds_read_b128 a[144:147], v7 offset:36864
  ds_read_b128 a[148:151], v7 offset:37888
  ds_read_b128 a[152:155], v7 offset:38912
  ds_read_b128 a[156:159], v7 offset:39936
  v_cvt_pk_bf16_f32 v66, v52, v53
  v_cvt_pk_bf16_f32 v67, v54, v55
  ds_write_b64 v9, v[66:67] offset:1024
  v_mfma_f32_16x16x32_bf16 v[40:43], v[104:107], a[104:107], v[40:43]
  v_mul_f32 v56, v24, v24
  v_mul_f32 v57, v25, v25
  v_mfma_f32_16x16x32_bf16 v[44:47], v[104:107], a[108:111], v[44:47]
  v_mul_f32 v58, v26, v26
  v_mul_f32 v59, v27, v27
  v_fma_f32 v56, v56, v13, v12
  s_waitcnt vmcnt(16) lgkmcnt(8)
  v_mfma_f32_16x16x32_bf16 v[32:35], v[108:111], a[112:115], v[32:35]
  buffer_load_dwordx4 v[104:107], v3, s[8:11], s45 offen offset:2048
  v_fma_f32 v57, v57, v13, v12
  v_fma_f32 v58, v58, v13, v12
  v_fma_f32 v59, v59, v13, v12
  v_mfma_f32_16x16x32_bf16 v[36:39], v[108:111], a[116:119], v[36:39]
  ds_read_b128 a[160:163], v7 offset:40960
  ds_read_b128 a[164:167], v7 offset:41984
  ds_read_b128 a[168:171], v7 offset:43008
  ds_read_b128 a[172:175], v7 offset:44032
  v_mul_f32 v56, v56, v24
  v_mul_f32 v57, v57, v25
  v_mul_f32 v58, v58, v26
  v_mfma_f32_16x16x32_bf16 v[40:43], v[108:111], a[120:123], v[40:43]
  v_mul_f32 v59, v59, v27
  v_exp_f32 v56, v56
  v_exp_f32 v57, v57
  v_mfma_f32_16x16x32_bf16 v[44:47], v[108:111], a[124:127], v[44:47]
  v_exp_f32 v58, v58
  v_exp_f32 v59, v59
  s_waitcnt vmcnt(16) lgkmcnt(8)
  v_mfma_f32_16x16x32_bf16 v[32:35], v[112:115], a[128:131], v[32:35]
  buffer_load_dwordx4 v[108:111], v3, s[8:11], s45 offen offset:3072
  v_add_f32 v56, 1.0, v56
  v_add_f32 v57, 1.0, v57
  v_add_f32 v58, 1.0, v58
  v_mfma_f32_16x16x32_bf16 v[36:39], v[112:115], a[132:135], v[36:39]
  ds_read_b128 a[176:179], v7 offset:45056
  ds_read_b128 a[180:183], v7 offset:46080
  ds_read_b128 a[184:187], v7 offset:47104
  ds_read_b128 a[188:191], v7 offset:48128
  v_add_f32 v59, 1.0, v59
  v_rcp_f32 v56, v56
  v_rcp_f32 v57, v57
  v_mfma_f32_16x16x32_bf16 v[40:43], v[112:115], a[136:139], v[40:43]
  v_rcp_f32 v58, v58
  v_rcp_f32 v59, v59
  v_mul_f32 v56, v24, v56
  v_mfma_f32_16x16x32_bf16 v[44:47], v[112:115], a[140:143], v[44:47]
  v_mul_f32 v57, v25, v57
  v_mul_f32 v58, v26, v58
  v_mul_f32 v59, v27, v59
  s_waitcnt vmcnt(16) lgkmcnt(8)
  v_mfma_f32_16x16x32_bf16 v[32:35], v[116:119], a[144:147], v[32:35]
  buffer_load_dwordx4 v[112:115], v4, s[8:11], s45 offen offset:0
  v_cvt_pk_bf16_f32 v68, v56, v57
  v_cvt_pk_bf16_f32 v69, v58, v59
  ds_write_b64 v9, v[68:69] offset:2048
  v_mfma_f32_16x16x32_bf16 v[36:39], v[116:119], a[148:151], v[36:39]
  ds_read_b128 a[192:195], v7 offset:49152
  ds_read_b128 a[196:199], v7 offset:50176
  ds_read_b128 a[200:203], v7 offset:51200
  ds_read_b128 a[204:207], v7 offset:52224
  v_mul_f32 v60, v28, v28
  v_mul_f32 v61, v29, v29
  v_mfma_f32_16x16x32_bf16 v[40:43], v[116:119], a[152:155], v[40:43]
  v_mul_f32 v62, v30, v30
  v_mul_f32 v63, v31, v31
  v_fma_f32 v60, v60, v13, v12
  v_mfma_f32_16x16x32_bf16 v[44:47], v[116:119], a[156:159], v[44:47]
  v_fma_f32 v61, v61, v13, v12
  v_fma_f32 v62, v62, v13, v12
  v_fma_f32 v63, v63, v13, v12
  s_waitcnt vmcnt(16) lgkmcnt(8)
  v_mfma_f32_16x16x32_bf16 v[32:35], v[120:123], a[160:163], v[32:35]
  buffer_load_dwordx4 v[116:119], v4, s[8:11], s45 offen offset:1024
  v_mul_f32 v60, v60, v28
  v_mul_f32 v61, v61, v29
  v_mul_f32 v62, v62, v30
  v_mfma_f32_16x16x32_bf16 v[36:39], v[120:123], a[164:167], v[36:39]
  ds_read_b128 a[208:211], v7 offset:53248
  ds_read_b128 a[212:215], v7 offset:54272
  ds_read_b128 a[216:219], v7 offset:55296
  ds_read_b128 a[220:223], v7 offset:56320
  v_mul_f32 v63, v63, v31
  v_exp_f32 v60, v60
  v_exp_f32 v61, v61
  v_mfma_f32_16x16x32_bf16 v[40:43], v[120:123], a[168:171], v[40:43]
  v_exp_f32 v62, v62
  v_exp_f32 v63, v63
  v_mfma_f32_16x16x32_bf16 v[44:47], v[120:123], a[172:175], v[44:47]
  v_add_f32 v60, 1.0, v60
  v_add_f32 v61, 1.0, v61
  v_add_f32 v62, 1.0, v62
  s_waitcnt vmcnt(16) lgkmcnt(8)
  v_mfma_f32_16x16x32_bf16 v[32:35], v[124:127], a[176:179], v[32:35]
  buffer_load_dwordx4 v[120:123], v4, s[8:11], s45 offen offset:2048
  v_add_f32 v63, 1.0, v63
  v_rcp_f32 v60, v60
  v_rcp_f32 v61, v61
  v_mfma_f32_16x16x32_bf16 v[36:39], v[124:127], a[180:183], v[36:39]
  ds_read_b128 a[224:227], v7 offset:57344
  ds_read_b128 a[228:231], v7 offset:58368
  ds_read_b128 a[232:235], v7 offset:59392
  ds_read_b128 a[236:239], v7 offset:60416
  v_rcp_f32 v62, v62
  v_rcp_f32 v63, v63
  v_mul_f32 v60, v28, v60
  v_mfma_f32_16x16x32_bf16 v[40:43], v[124:127], a[184:187], v[40:43]
  v_mul_f32 v61, v29, v61
  v_mul_f32 v62, v30, v62
  v_mul_f32 v63, v31, v63
  v_mfma_f32_16x16x32_bf16 v[44:47], v[124:127], a[188:191], v[44:47]
  v_cvt_pk_bf16_f32 v70, v60, v61
  v_cvt_pk_bf16_f32 v71, v62, v63
  ds_write_b64 v9, v[70:71] offset:3072
  s_waitcnt vmcnt(16) lgkmcnt(8)
  v_mfma_f32_16x16x32_bf16 v[32:35], v[128:131], a[192:195], v[32:35]
  buffer_load_dwordx4 v[124:127], v4, s[8:11], s45 offen offset:3072
  v_mfma_f32_16x16x32_bf16 v[36:39], v[128:131], a[196:199], v[36:39]
  ds_read_b128 a[240:243], v7 offset:61440
  ds_read_b128 a[244:247], v7 offset:62464
  ds_read_b128 a[248:251], v7 offset:63488
  ds_read_b128 a[252:255], v7 offset:64512
  v_mfma_f32_16x16x32_bf16 v[40:43], v[128:131], a[200:203], v[40:43]
  v_mfma_f32_16x16x32_bf16 v[44:47], v[128:131], a[204:207], v[44:47]
  s_waitcnt lgkmcnt(0)
  s_barrier
  ds_read_b128 v[224:227], v8 offset:0
  ds_read_b128 v[228:231], v8 offset:1024
  ds_read_b128 v[232:235], v8 offset:2048
  ds_read_b128 v[236:239], v8 offset:3072
  ds_read_b128 v[240:243], v8 offset:4096
  ds_read_b128 v[244:247], v8 offset:5120
  ds_read_b128 v[248:251], v8 offset:6144
  ds_read_b128 v[252:255], v8 offset:7168
  s_waitcnt vmcnt(16) lgkmcnt(15)
  v_mfma_f32_16x16x32_bf16 v[32:35], v[132:135], a[208:211], v[32:35]
  buffer_load_dwordx4 v[128:131], v5, s[8:11], s45 offen offset:0
  v_mfma_f32_16x16x32_bf16 v[36:39], v[132:135], a[212:215], v[36:39]
  v_mfma_f32_16x16x32_bf16 v[40:43], v[132:135], a[216:219], v[40:43]
  v_mfma_f32_16x16x32_bf16 v[44:47], v[132:135], a[220:223], v[44:47]
  s_waitcnt vmcnt(16) lgkmcnt(12)
  v_mfma_f32_16x16x32_bf16 v[32:35], v[136:139], a[224:227], v[32:35]
  buffer_load_dwordx4 v[132:135], v5, s[8:11], s45 offen offset:1024
  v_mfma_f32_16x16x32_bf16 v[36:39], v[136:139], a[228:231], v[36:39]
  v_mfma_f32_16x16x32_bf16 v[40:43], v[136:139], a[232:235], v[40:43]
  v_mfma_f32_16x16x32_bf16 v[44:47], v[136:139], a[236:239], v[44:47]
  s_waitcnt vmcnt(16) lgkmcnt(8)
  v_mfma_f32_16x16x32_bf16 v[32:35], v[140:143], a[240:243], v[32:35]
  buffer_load_dwordx4 v[136:139], v5, s[8:11], s45 offen offset:2048
  v_mfma_f32_16x16x32_bf16 v[36:39], v[140:143], a[244:247], v[36:39]
  v_mfma_f32_16x16x32_bf16 v[40:43], v[140:143], a[248:251], v[40:43]
  v_mfma_f32_16x16x32_bf16 v[44:47], v[140:143], a[252:255], v[44:47]
  s_waitcnt vmcnt(16) lgkmcnt(4)
  v_mfma_f32_16x16x32_bf16 v[32:35], v[144:147], v[224:227], v[32:35]
  buffer_load_dwordx4 v[140:143], v5, s[8:11], s45 offen offset:3072
  v_mfma_f32_16x16x32_bf16 v[36:39], v[144:147], v[228:231], v[36:39]
  v_mfma_f32_16x16x32_bf16 v[40:43], v[144:147], v[232:235], v[40:43]
  v_mfma_f32_16x16x32_bf16 v[44:47], v[144:147], v[236:239], v[44:47]
  s_waitcnt vmcnt(16) lgkmcnt(0)
  v_mfma_f32_16x16x32_bf16 v[32:35], v[148:151], v[240:243], v[32:35]
  buffer_load_dwordx4 v[144:147], v6, s[8:11], s45 offen offset:0
  v_mfma_f32_16x16x32_bf16 v[36:39], v[148:151], v[244:247], v[36:39]
  v_mfma_f32_16x16x32_bf16 v[40:43], v[148:151], v[248:251], v[40:43]
  v_mfma_f32_16x16x32_bf16 v[44:47], v[148:151], v[252:255], v[44:47]
  s_mov_b32 s43, 1
ffn_kernel_p2loop:
  s_lshl_b32 s50, s49, 13
  s_add_u32 s46, s60, s50
  s_mov_b32 s49, s59
  s_mov_b32 s44, s45
  s_add_u32 s59, s49, 1
  s_cmp_eq_u32 s59, 9
  s_cselect_b32 s59, 0, s59
  s_add_u32 s65, s59, 1
  s_cmp_eq_u32 s65, 9
  s_cselect_b32 s65, 0, s65
  s_mul_i32 s50, s59, 73728
  s_add_u32 s45, s48, s50
  s_mul_i32 s50, s65, 73728
  s_add_u32 s64, s48, s50
  s_waitcnt vmcnt(16)
  v_cvt_pk_bf16_f32 v64, v32, v33
  v_cvt_pk_bf16_f32 v65, v34, v35
  v_mfma_f32_16x16x32_bf16 v[32:35], v[80:83], a[0:3], 0
  buffer_load_dwordx4 v[148:151], v6, s[8:11], s44 offen offset:1024
  v_cvt_pk_bf16_f32 v66, v36, v37
  v_cvt_pk_bf16_f32 v67, v38, v39
  v_mfma_f32_16x16x32_bf16 v[36:39], v[80:83], a[4:7], 0
  v_cvt_pk_bf16_f32 v68, v40, v41
  v_cvt_pk_bf16_f32 v69, v42, v43
  v_mfma_f32_16x16x32_bf16 v[40:43], v[80:83], a[8:11], 0
  v_cvt_pk_bf16_f32 v70, v44, v45
  v_cvt_pk_bf16_f32 v71, v46, v47
  v_mfma_f32_16x16x32_bf16 v[44:47], v[80:83], a[12:15], 0
  s_waitcnt vmcnt(16)
  v_mfma_f32_16x16x32_bf16 v[32:35], v[84:87], a[16:19], v[32:35]
  s_cmp_lg_u32 s40, 0
  s_cbranch_scc1 L_st_p2_1
  buffer_store_dwordx4 v[64:67], v10, s[8:11], s46 offen sc1
  buffer_store_dwordx4 v[68:71], v10, s[8:11], s46 offen offset:1024 sc1
L_st_p2_1:
  buffer_load_dwordx4 v[80:83], v2, s[8:11], s45 offen offset:0
  v_mfma_f32_16x16x32_bf16 v[36:39], v[84:87], a[20:23], v[36:39]
  v_mfma_f32_16x16x32_bf16 v[40:43], v[84:87], a[24:27], v[40:43]
  v_mfma_f32_16x16x32_bf16 v[44:47], v[84:87], a[28:31], v[44:47]
  s_waitcnt vmcnt(16)
  v_mfma_f32_16x16x32_bf16 v[32:35], v[88:91], a[32:35], v[32:35]
  buffer_load_dwordx4 v[84:87], v2, s[8:11], s45 offen offset:1024
  v_mfma_f32_16x16x32_bf16 v[36:39], v[88:91], a[36:39], v[36:39]
  v_mfma_f32_16x16x32_bf16 v[40:43], v[88:91], a[40:43], v[40:43]
  v_mfma_f32_16x16x32_bf16 v[44:47], v[88:91], a[44:47], v[44:47]
  s_waitcnt vmcnt(16)
  v_mfma_f32_16x16x32_bf16 v[32:35], v[92:95], a[48:51], v[32:35]
  buffer_load_dwordx4 v[88:91], v2, s[8:11], s45 offen offset:2048
  v_mfma_f32_16x16x32_bf16 v[36:39], v[92:95], a[52:55], v[36:39]
  v_mfma_f32_16x16x32_bf16 v[40:43], v[92:95], a[56:59], v[40:43]
  v_mfma_f32_16x16x32_bf16 v[44:47], v[92:95], a[60:63], v[44:47]
  s_waitcnt vmcnt(16)
  v_mfma_f32_16x16x32_bf16 v[32:35], v[96:99], a[64:67], v[32:35]
  buffer_load_dwordx4 v[92:95], v2, s[8:11], s45 offen offset:3072
  v_mfma_f32_16x16x32_bf16 v[36:39], v[96:99], a[68:71], v[36:39]
  v_mfma_f32_16x16x32_bf16 v[40:43], v[96:99], a[72:75], v[40:43]
  v_mfma_f32_16x16x32_bf16 v[44:47], v[96:99], a[76:79], v[44:47]
  s_waitcnt vmcnt(16)
  v_mfma_f32_16x16x32_bf16 v[32:35], v[100:103], a[80:83], v[32:35]
  s_cmp_lg_u32 s40, 1
  s_cbranch_scc1 L_st_p2_5
  buffer_store_dwordx4 v[64:67], v10, s[8:11], s46 offen sc1
  buffer_store_dwordx4 v[68:71], v10, s[8:11], s46 offen offset:1024 sc1
L_st_p2_5:
  buffer_load_dwordx4 v[96:99], v3, s[8:11], s45 offen offset:0
  v_mfma_f32_16x16x32_bf16 v[36:39], v[100:103], a[84:87], v[36:39]
  v_mfma_f32_16x16x32_bf16 v[40:43], v[100:103], a[88:91], v[40:43]
  v_mfma_f32_16x16x32_bf16 v[44:47], v[100:103], a[92:95], v[44:47]
  s_waitcnt vmcnt(16)
  v_mfma_f32_16x16x32_bf16 v[32:35], v[104:107], a[96:99], v[32:35]
  buffer_load_dwordx4 v[100:103], v3, s[8:11], s45 offen offset:1024
  v_mfma_f32_16x16x32_bf16 v[36:39], v[104:107], a[100:103], v[36:39]
  v_mfma_f32_16x16x32_bf16 v[40:43], v[104:107], a[104:107], v[40:43]
  v_mfma_f32_16x16x32_bf16 v[44:47], v[104:107], a[108:111], v[44:47]
  s_waitcnt vmcnt(16)
  v_mfma_f32_16x16x32_bf16 v[32:35], v[108:111], a[112:115], v[32:35]
  buffer_load_dwordx4 v[104:107], v3, s[8:11], s45 offen offset:2048
  v_mfma_f32_16x16x32_bf16 v[36:39], v[108:111], a[116:119], v[36:39]
  v_mfma_f32_16x16x32_bf16 v[40:43], v[108:111], a[120:123], v[40:43]
  v_mfma_f32_16x16x32_bf16 v[44:47], v[108:111], a[124:127], v[44:47]
  s_waitcnt vmcnt(16)
  v_mfma_f32_16x16x32_bf16 v[32:35], v[112:115], a[128:131], v[32:35]
  buffer_load_dwordx4 v[108:111], v3, s[8:11], s45 offen offset:3072
  v_mfma_f32_16x16x32_bf16 v[36:39], v[112:115], a[132:135], v[36:39]
  v_mfma_f32_16x16x32_bf16 v[40:43], v[112:115], a[136:139], v[40:43]
  v_mfma_f32_16x16x32_bf16 v[44:47], v[112:115], a[140:143], v[44:47]
  s_waitcnt vmcnt(16)
  v_mfma_f32_16x16x32_bf16 v[32:35], v[116:119], a[144:147], v[32:35]
  s_cmp_lg_u32 s40, 2
  s_cbranch_scc1 L_st_p2_9
  buffer_store_dwordx4 v[64:67], v10, s[8:11], s46 offen sc1
  buffer_store_dwordx4 v[68:71], v10, s[8:11], s46 offen offset:1024 sc1
L_st_p2_9:
  buffer_load_dwordx4 v[112:115], v4, s[8:11], s45 offen offset:0
  v_mfma_f32_16x16x32_bf16 v[36:39], v[116:119], a[148:151], v[36:39]
  v_mfma_f32_16x16x32_bf16 v[40:43], v[116:119], a[152:155], v[40:43]
  v_mfma_f32_16x16x32_bf16 v[44:47], v[116:119], a[156:159], v[44:47]
  s_waitcnt vmcnt(16)
  v_mfma_f32_16x16x32_bf16 v[32:35], v[120:123], a[160:163], v[32:35]
  buffer_load_dwordx4 v[116:119], v4, s[8:11], s45 offen offset:1024
  v_mfma_f32_16x16x32_bf16 v[36:39], v[120:123], a[164:167], v[36:39]
  v_mfma_f32_16x16x32_bf16 v[40:43], v[120:123], a[168:171], v[40:43]
  v_mfma_f32_16x16x32_bf16 v[44:47], v[120:123], a[172:175], v[44:47]
  s_waitcnt vmcnt(16)
  v_mfma_f32_16x16x32_bf16 v[32:35], v[124:127], a[176:179], v[32:35]
  buffer_load_dwordx4 v[120:123], v4, s[8:11], s45 offen offset:2048
  v_mfma_f32_16x16x32_bf16 v[36:39], v[124:127], a[180:183], v[36:39]
  v_mfma_f32_16x16x32_bf16 v[40:43], v[124:127], a[184:187], v[40:43]
  v_mfma_f32_16x16x32_bf16 v[44:47], v[124:127], a[188:191], v[44:47]
  s_waitcnt vmcnt(16)
  v_mfma_f32_16x16x32_bf16 v[32:35], v[128:131], a[192:195], v[32:35]
  buffer_load_dwordx4 v[124:127], v4, s[8:11], s45 offen offset:3072
  v_mfma_f32_16x16x32_bf16 v[36:39], v[128:131], a[196:199], v[36:39]
  v_mfma_f32_16x16x32_bf16 v[40:43], v[128:131], a[200:203], v[40:43]
  v_mfma_f32_16x16x32_bf16 v[44:47], v[128:131], a[204:207], v[44:47]
  s_waitcnt vmcnt(16)
  v_mfma_f32_16x16x32_bf16 v[32:35], v[132:135], a[208:211], v[32:35]
  s_cmp_lg_u32 s40, 3
  s_cbranch_scc1 L_st_p2_13
  buffer_store_dwordx4 v[64:67], v10, s[8:11], s46 offen sc1
  buffer_store_dwordx4 v[68:71], v10, s[8:11], s46 offen offset:1024 sc1
L_st_p2_13:
  buffer_load_dwordx4 v[128:131], v5, s[8:11], s45 offen offset:0
  v_mfma_f32_16x16x32_bf16 v[36:39], v[132:135], a[212:215], v[36:39]
  v_mfma_f32_16x16x32_bf16 v[40:43], v[132:135], a[216:219], v[40:43]
  v_mfma_f32_16x16x32_bf16 v[44:47], v[132:135], a[220:223], v[44:47]
  s_waitcnt vmcnt(16)
  v_mfma_f32_16x16x32_bf16 v[32:35], v[136:139], a[224:227], v[32:35]
  buffer_load_dwordx4 v[132:135], v5, s[8:11], s45 offen offset:1024
  v_mfma_f32_16x16x32_bf16 v[36:39], v[136:139], a[228:231], v[36:39]
  v_mfma_f32_16x16x32_bf16 v[40:43], v[136:139], a[232:235], v[40:43]
  v_mfma_f32_16x16x32_bf16 v[44:47], v[136:139], a[236:239], v[44:47]
  s_waitcnt vmcnt(16)
  v_mfma_f32_16x16x32_bf16 v[32:35], v[140:143], a[240:243], v[32:35]
  buffer_load_dwordx4 v[136:139], v5, s[8:11], s45 offen offset:2048
  v_mfma_f32_16x16x32_bf16 v[36:39], v[140:143], a[244:247], v[36:39]
  v_mfma_f32_16x16x32_bf16 v[40:43], v[140:143], a[248:251], v[40:43]
  v_mfma_f32_16x16x32_bf16 v[44:47], v[140:143], a[252:255], v[44:47]
  s_waitcnt vmcnt(16)
  v_mfma_f32_16x16x32_bf16 v[32:35], v[144:147], v[224:227], v[32:35]
  buffer_load_dwordx4 v[140:143], v5, s[8:11], s45 offen offset:3072
  v_mfma_f32_16x16x32_bf16 v[36:39], v[144:147], v[228:231], v[36:39]
  v_mfma_f32_16x16x32_bf16 v[40:43], v[144:147], v[232:235], v[40:43]
  v_mfma_f32_16x16x32_bf16 v[44:47], v[144:147], v[236:239], v[44:47]
  s_waitcnt vmcnt(16)
  v_mfma_f32_16x16x32_bf16 v[32:35], v[148:151], v[240:243], v[32:35]
  buffer_load_dwordx4 v[144:147], v6, s[8:11], s45 offen offset:0
  v_mfma_f32_16x16x32_bf16 v[36:39], v[148:151], v[244:247], v[36:39]
  v_mfma_f32_16x16x32_bf16 v[40:43], v[148:151], v[248:251], v[40:43]
  v_mfma_f32_16x16x32_bf16 v[44:47], v[148:151], v[252:255], v[44:47]
  s_add_u32 s43, s43, 1
  s_cmp_lt_u32 s43, 9
  s_cbranch_scc1 ffn_kernel_p2loop
  s_lshl_b32 s50, s49, 13
  s_add_u32 s46, s60, s50
  s_nop 7
  v_cvt_pk_bf16_f32 v64, v32, v33
  v_cvt_pk_bf16_f32 v65, v34, v35
  v_cvt_pk_bf16_f32 v66, v36, v37
  v_cvt_pk_bf16_f32 v67, v38, v39
  v_cvt_pk_bf16_f32 v68, v40, v41
  v_cvt_pk_bf16_f32 v69, v42, v43
  v_cvt_pk_bf16_f32 v70, v44, v45
  v_cvt_pk_bf16_f32 v71, v46, v47
  buffer_store_dwordx4 v[64:67], v10, s[8:11], s46 offen sc1
  buffer_store_dwordx4 v[68:71], v10, s[8:11], s46 offen offset:1024 sc1
ffn_kernel_end:
  s_endpgm
.globl red_kernel
.p2align 8
.type red_kernel,@function
red_kernel:
  s_cmp_ge_u32 s2, 256
  s_cbranch_scc1 red_kernel_end
  s_load_dwordx2 s[4:5], s[0:1], 88
  s_load_dwordx2 s[6:7], s[0:1], 64
  s_load_dwordx2 s[36:37], s[0:1], 72
  v_and_b32 v1, 63, v0
  v_lshrrev_b32 v2, 6, v0
  s_nop 0
  v_readfirstlane_b32 s40, v2
  s_lshr_b32 s41, s2, 3
  s_and_b32 s42, s2, 3
  s_lshr_b32 s43, s2, 2
  s_and_b32 s43, s43, 1
  v_lshlrev_b32 v3, 4, v1
  v_lshrrev_b32 v4, 4, v1
  v_and_b32 v5, 15, v1
  v_lshlrev_b32 v6, 3, v4
  v_mul_u32_u24 v7, 1152, v5
  v_add_u32 v7, v7, v6
  s_mul_i32 s44, s42, 9
  s_mul_i32 s45, s40, 3
  s_add_u32 s44, s44, s45
  s_waitcnt lgkmcnt(0)
  s_mov_b32 s8, s4
  s_and_b32 s9, s5, 0xffff
  s_mov_b32 s10, 39313408
  s_mov_b32 s11, 0x20000
  s_mov_b32 s12, s6
  s_and_b32 s13, s7, 0xffff
  s_mov_b32 s14, 1152
  s_mov_b32 s15, 0x20000
  s_mov_b32 s16, s36
  s_and_b32 s17, s37, 0xffff
  s_mov_b32 s18, 2359296
  s_mov_b32 s19, 0x20000
  s_mul_i32 s46, s41, 576
  s_lshl_b32 s47, s44, 1
  s_add_u32 s46, s46, s47
  s_add_u32 s46, s46, s43
  s_lshl_b32 s46, s46, 10
  s_add_u32 s46, s46, 13639680
  s_lshl_b32 s48, s41, 2
  s_lshl_b32 s49, s43, 1
  s_add_u32 s48, s48, s49
  s_add_u32 s50, s46, 0
  buffer_load_dwordx4 v[16:19], v3, s[8:11], s50 offen
  s_add_u32 s50, s46, 73728
  buffer_load_dwordx4 v[20:23], v3, s[8:11], s50 offen
  s_add_u32 s50, s46, 147456
  buffer_load_dwordx4 v[24:27], v3, s[8:11], s50 offen
  s_add_u32 s50, s46, 221184
  buffer_load_dwordx4 v[28:31], v3, s[8:11], s50 offen
  s_add_u32 s50, s46, 294912
  buffer_load_dwordx4 v[32:35], v3, s[8:11], s50 offen
  s_add_u32 s50, s46, 368640
  buffer_load_dwordx4 v[36:39], v3, s[8:11], s50 offen
  s_add_u32 s50, s46, 442368
  buffer_load_dwordx4 v[40:43], v3, s[8:11], s50 offen
  s_add_u32 s50, s46, 516096
  buffer_load_dwordx4 v[44:47], v3, s[8:11], s50 offen
  s_add_u32 s51, s44, 0
  s_lshr_b32 s52, s51, 1
  s_and_b32 s53, s51, 1
  s_lshl_b32 s53, s53, 3
  s_add_u32 s54, s48, 0
  s_mul_i32 s54, s54, 18
  s_add_u32 s54, s54, s52
  s_lshl_b32 s54, s54, 10
  s_add_u32 s54, s54, s53
  s_add_u32 s54, s54, 11280384
  buffer_load_dwordx2 v[48:49], v3, s[8:11], s54 offen
  s_add_u32 s54, s48, 1
  s_mul_i32 s54, s54, 18
  s_add_u32 s54, s54, s52
  s_lshl_b32 s54, s54, 10
  s_add_u32 s54, s54, s53
  s_add_u32 s54, s54, 11280384
  buffer_load_dwordx2 v[50:51], v3, s[8:11], s54 offen
  s_lshl_b32 s55, s51, 5
  buffer_load_dwordx2 v[52:53], v6, s[12:15], s55 offen
  s_add_u32 s50, s46, 2048
  buffer_load_dwordx4 v[54:57], v3, s[8:11], s50 offen
  s_add_u32 s50, s46, 75776
  buffer_load_dwordx4 v[58:61], v3, s[8:11], s50 offen
  s_add_u32 s50, s46, 149504
  buffer_load_dwordx4 v[62:65], v3, s[8:11], s50 offen
  s_add_u32 s50, s46, 223232
  buffer_load_dwordx4 v[66:69], v3, s[8:11], s50 offen
  s_add_u32 s50, s46, 296960
  buffer_load_dwordx4 v[70:73], v3, s[8:11], s50 offen
  s_add_u32 s50, s46, 370688
  buffer_load_dwordx4 v[74:77], v3, s[8:11], s50 offen
  s_add_u32 s50, s46, 444416
  buffer_load_dwordx4 v[78:81], v3, s[8:11], s50 offen
  s_add_u32 s50, s46, 518144
  buffer_load_dwordx4 v[82:85], v3, s[8:11], s50 offen
  s_add_u32 s51, s44, 1
  s_lshr_b32 s52, s51, 1
  s_and_b32 s53, s51, 1
  s_lshl_b32 s53, s53, 3
  s_add_u32 s54, s48, 0
  s_mul_i32 s54, s54, 18
  s_add_u32 s54, s54, s52
  s_lshl_b32 s54, s54, 10
  s_add_u32 s54, s54, s53
  s_add_u32 s54, s54, 11280384
  buffer_load_dwordx2 v[86:87], v3, s[8:11], s54 offen
  s_add_u32 s54, s48, 1
  s_mul_i32 s54, s54, 18
  s_add_u32 s54, s54, s52
  s_lshl_b32 s54, s54, 10
  s_add_u32 s54, s54, s53
  s_add_u32 s54, s54, 11280384
  buffer_load_dwordx2 v[88:89], v3, s[8:11], s54 offen
  s_lshl_b32 s55, s51, 5
  buffer_load_dwordx2 v[90:91], v6, s[12:15], s55 offen
  s_add_u32 s50, s46, 4096
  buffer_load_dwordx4 v[92:95], v3, s[8:11], s50 offen
  s_add_u32 s50, s46, 77824
  buffer_load_dwordx4 v[96:99], v3, s[8:11], s50 offen
  s_add_u32 s50, s46, 151552
  buffer_load_dwordx4 v[100:103], v3, s[8:11], s50 offen
  s_add_u32 s50, s46, 225280
  buffer_load_dwordx4 v[104:107], v3, s[8:11], s50 offen
  s_add_u32 s50, s46, 299008
  buffer_load_dwordx4 v[108:111], v3, s[8:11], s50 offen
  s_add_u32 s50, s46, 372736
  buffer_load_dwordx4 v[112:115], v3, s[8:11], s50 offen
  s_add_u32 s50, s46, 446464
  buffer_load_dwordx4 v[116:119], v3, s[8:11], s50 offen
  s_add_u32 s50, s46, 520192
  buffer_load_dwordx4 v[120:123], v3, s[8:11], s50 offen
  s_add_u32 s51, s44, 2
  s_lshr_b32 s52, s51, 1
  s_and_b32 s53, s51, 1
  s_lshl_b32 s53, s53, 3
  s_add_u32 s54, s48, 0
  s_mul_i32 s54, s54, 18
  s_add_u32 s54, s54, s52
  s_lshl_b32 s54, s54, 10
  s_add_u32 s54, s54, s53
  s_add_u32 s54, s54, 11280384
  buffer_load_dwordx2 v[124:125], v3, s[8:11], s54 offen
  s_add_u32 s54, s48, 1
  s_mul_i32 s54, s54, 18
  s_add_u32 s54, s54, s52
  s_lshl_b32 s54, s54, 10
  s_add_u32 s54, s54, s53
  s_add_u32 s54, s54, 11280384
  buffer_load_dwordx2 v[126:127], v3, s[8:11], s54 offen
  s_lshl_b32 s55, s51, 5
  buffer_load_dwordx2 v[128:129], v6, s[12:15], s55 offen
  s_mov_b32 s60, 0x00003f80
  s_mov_b32 s61, 0x3f800000
  s_waitcnt vmcnt(22)
  v_lshlrev_b32 v132, 16, v52
  v_and_b32 v133, 0xffff0000, v52
  v_lshlrev_b32 v134, 16, v53
  v_and_b32 v135, 0xffff0000, v53
  v_lshlrev_b32 v136, 16, v52
  v_and_b32 v137, 0xffff0000, v52
  v_lshlrev_b32 v138, 16, v53
  v_and_b32 v139, 0xffff0000, v53
  v_dot2c_f32_bf16 v132, s60, v16
  v_dot2c_f32_bf16 v133, s61, v16
  v_dot2c_f32_bf16 v134, s60, v17
  v_dot2c_f32_bf16 v135, s61, v17
  v_dot2c_f32_bf16 v136, s60, v18
  v_dot2c_f32_bf16 v137, s61, v18
  v_dot2c_f32_bf16 v138, s60, v19
  v_dot2c_f32_bf16 v139, s61, v19
  v_dot2c_f32_bf16 v132, s60, v20
  v_dot2c_f32_bf16 v133, s61, v20
  v_dot2c_f32_bf16 v134, s60, v21
  v_dot2c_f32_bf16 v135, s61, v21
  v_dot2c_f32_bf16 v136, s60, v22
  v_dot2c_f32_bf16 v137, s61, v22
  v_dot2c_f32_bf16 v138, s60, v23
  v_dot2c_f32_bf16 v139, s61, v23
  v_dot2c_f32_bf16 v132, s60, v24
  v_dot2c_f32_bf16 v133, s61, v24
  v_dot2c_f32_bf16 v134, s60, v25
  v_dot2c_f32_bf16 v135, s61, v25
  v_dot2c_f32_bf16 v136, s60, v26
  v_dot2c_f32_bf16 v137, s61, v26
  v_dot2c_f32_bf16 v138, s60, v27
  v_dot2c_f32_bf16 v139, s61, v27
  v_dot2c_f32_bf16 v132, s60, v28
  v_dot2c_f32_bf16 v133, s61, v28
  v_dot2c_f32_bf16 v134, s60, v29
  v_dot2c_f32_bf16 v135, s61, v29
  v_dot2c_f32_bf16 v136, s60, v30
  v_dot2c_f32_bf16 v137, s61, v30
  v_dot2c_f32_bf16 v138, s60, v31
  v_dot2c_f32_bf16 v139, s61, v31
  v_dot2c_f32_bf16 v132, s60, v32
  v_dot2c_f32_bf16 v133, s61, v32
  v_dot2c_f32_bf16 v134, s60, v33
  v_dot2c_f32_bf16 v135, s61, v33
  v_dot2c_f32_bf16 v136, s60, v34
  v_dot2c_f32_bf16 v137, s61, v34
  v_dot2c_f32_bf16 v138, s60, v35
  v_dot2c_f32_bf16 v139, s61, v35
  v_dot2c_f32_bf16 v132, s60, v36
  v_dot2c_f32_bf16 v133, s61, v36
  v_dot2c_f32_bf16 v134, s60, v37
  v_dot2c_f32_bf16 v135, s61, v37
  v_dot2c_f32_bf16 v136, s60, v38
  v_dot2c_f32_bf16 v137, s61, v38
  v_dot2c_f32_bf16 v138, s60, v39
  v_dot2c_f32_bf16 v139, s61, v39
  v_dot2c_f32_bf16 v132, s60, v40
  v_dot2c_f32_bf16 v133, s61, v40
  v_dot2c_f32_bf16 v134, s60, v41
  v_dot2c_f32_bf16 v135, s61, v41
  v_dot2c_f32_bf16 v136, s60, v42
  v_dot2c_f32_bf16 v137, s61, v42
  v_dot2c_f32_bf16 v138, s60, v43
  v_dot2c_f32_bf16 v139, s61, v43
  v_dot2c_f32_bf16 v132, s60, v44
  v_dot2c_f32_bf16 v133, s61, v44
  v_dot2c_f32_bf16 v134, s60, v45
  v_dot2c_f32_bf16 v135, s61, v45
  v_dot2c_f32_bf16 v136, s60, v46
  v_dot2c_f32_bf16 v137, s61, v46
  v_dot2c_f32_bf16 v138, s60, v47
  v_dot2c_f32_bf16 v139, s61, v47
  v_dot2c_f32_bf16 v132, s60, v48
  v_dot2c_f32_bf16 v133, s61, v48
  v_dot2c_f32_bf16 v134, s60, v49
  v_dot2c_f32_bf16 v135, s61, v49
  v_dot2c_f32_bf16 v136, s60, v50
  v_dot2c_f32_bf16 v137, s61, v50
  v_dot2c_f32_bf16 v138, s60, v51
  v_dot2c_f32_bf16 v139, s61, v51
  s_nop 2
  v_cvt_pk_bf16_f32 v140, v132, v133
  v_cvt_pk_bf16_f32 v141, v134, v135
  v_cvt_pk_bf16_f32 v142, v136, v137
  v_cvt_pk_bf16_f32 v143, v138, v139
  s_add_u32 s54, s48, 0
  s_mul_i32 s54, s54, 18432
  s_add_u32 s51, s44, 0
  s_lshl_b32 s51, s51, 5
  s_add_u32 s54, s54, s51
  buffer_store_dwordx2 v[140:141], v7, s[16:19], s54 offen
  s_add_u32 s54, s48, 1
  s_mul_i32 s54, s54, 18432
  s_add_u32 s51, s44, 0
  s_lshl_b32 s51, s51, 5
  s_add_u32 s54, s54, s51
  buffer_store_dwordx2 v[142:143], v7, s[16:19], s54 offen
  s_nop 1
  s_waitcnt vmcnt(13)
  v_lshlrev_b32 v132, 16, v90
  v_and_b32 v133, 0xffff0000, v90
  v_lshlrev_b32 v134, 16, v91
  v_and_b32 v135, 0xffff0000, v91
  v_lshlrev_b32 v136, 16, v90
  v_and_b32 v137, 0xffff0000, v90
  v_lshlrev_b32 v138, 16, v91
  v_and_b32 v139, 0xffff0000, v91
  v_dot2c_f32_bf16 v132, s60, v54
  v_dot2c_f32_bf16 v133, s61, v54
  v_dot2c_f32_bf16 v134, s60, v55
  v_dot2c_f32_bf16 v135, s61, v55
  v_dot2c_f32_bf16 v136, s60, v56
  v_dot2c_f32_bf16 v137, s61, v56
  v_dot2c_f32_bf16 v138, s60, v57
  v_dot2c_f32_bf16 v139, s61, v57
  v_dot2c_f32_bf16 v132, s60, v58
  v_dot2c_f32_bf16 v133, s61, v58
  v_dot2c_f32_bf16 v134, s60, v59
  v_dot2c_f32_bf16 v135, s61, v59
  v_dot2c_f32_bf16 v136, s60, v60
  v_dot2c_f32_bf16 v137, s61, v60
  v_dot2c_f32_bf16 v138, s60, v61
  v_dot2c_f32_bf16 v139, s61, v61
  v_dot2c_f32_bf16 v132, s60, v62
  v_dot2c_f32_bf16 v133, s61, v62
  v_dot2c_f32_bf16 v134, s60, v63
  v_dot2c_f32_bf16 v135, s61, v63
  v_dot2c_f32_bf16 v136, s60, v64
  v_dot2c_f32_bf16 v137, s61, v64
  v_dot2c_f32_bf16 v138, s60, v65
  v_dot2c_f32_bf16 v139, s61, v65
  v_dot2c_f32_bf16 v132, s60, v66
  v_dot2c_f32_bf16 v133, s61, v66
  v_dot2c_f32_bf16 v134, s60, v67
  v_dot2c_f32_bf16 v135, s61, v67
  v_dot2c_f32_bf16 v136, s60, v68
  v_dot2c_f32_bf16 v137, s61, v68
  v_dot2c_f32_bf16 v138, s60, v69
  v_dot2c_f32_bf16 v139, s61, v69
  v_dot2c_f32_bf16 v132, s60, v70
  v_dot2c_f32_bf16 v133, s61, v70
  v_dot2c_f32_bf16 v134, s60, v71
  v_dot2c_f32_bf16 v135, s61, v71
  v_dot2c_f32_bf16 v136, s60, v72
  v_dot2c_f32_bf16 v137, s61, v72
  v_dot2c_f32_bf16 v138, s60, v73
  v_dot2c_f32_bf16 v139, s61, v73
  v_dot2c_f32_bf16 v132, s60, v74
  v_dot2c_f32_bf16 v133, s61, v74
  v_dot2c_f32_bf16 v134, s60, v75
  v_dot2c_f32_bf16 v135, s61, v75
  v_dot2c_f32_bf16 v136, s60, v76
  v_dot2c_f32_bf16 v137, s61, v76
  v_dot2c_f32_bf16 v138, s60, v77
  v_dot2c_f32_bf16 v139, s61, v77
  v_dot2c_f32_bf16 v132, s60, v78
  v_dot2c_f32_bf16 v133, s61, v78
  v_dot2c_f32_bf16 v134, s60, v79
  v_dot2c_f32_bf16 v135, s61, v79
  v_dot2c_f32_bf16 v136, s60, v80
  v_dot2c_f32_bf16 v137, s61, v80
  v_dot2c_f32_bf16 v138, s60, v81
  v_dot2c_f32_bf16 v139, s61, v81
  v_dot2c_f32_bf16 v132, s60, v82
  v_dot2c_f32_bf16 v133, s61, v82
  v_dot2c_f32_bf16 v134, s60, v83
  v_dot2c_f32_bf16 v135, s61, v83
  v_dot2c_f32_bf16 v136, s60, v84
  v_dot2c_f32_bf16 v137, s61, v84
  v_dot2c_f32_bf16 v138, s60, v85
  v_dot2c_f32_bf16 v139, s61, v85
  v_dot2c_f32_bf16 v132, s60, v86
  v_dot2c_f32_bf16 v133, s61, v86
  v_dot2c_f32_bf16 v134, s60, v87
  v_dot2c_f32_bf16 v135, s61, v87
  v_dot2c_f32_bf16 v136, s60, v88
  v_dot2c_f32_bf16 v137, s61, v88
  v_dot2c_f32_bf16 v138, s60, v89
  v_dot2c_f32_bf16 v139, s61, v89
  s_nop 2
  v_cvt_pk_bf16_f32 v140, v132, v133
  v_cvt_pk_bf16_f32 v141, v134, v135
  v_cvt_pk_bf16_f32 v142, v136, v137
  v_cvt_pk_bf16_f32 v143, v138, v139
  s_add_u32 s54, s48, 0
  s_mul_i32 s54, s54, 18432
  s_add_u32 s51, s44, 1
  s_lshl_b32 s51, s51, 5
  s_add_u32 s54, s54, s51
  buffer_store_dwordx2 v[140:141], v7, s[16:19], s54 offen
  s_add_u32 s54, s48, 1
  s_mul_i32 s54, s54, 18432
  s_add_u32 s51, s44, 1
  s_lshl_b32 s51, s51, 5
  s_add_u32 s54, s54, s51
  buffer_store_dwordx2 v[142:143], v7, s[16:19], s54 offen
  s_nop 1
  s_waitcnt vmcnt(4)
  v_lshlrev_b32 v132, 16, v128
  v_and_b32 v133, 0xffff0000, v128
  v_lshlrev_b32 v134, 16, v129
  v_and_b32 v135, 0xffff0000, v129
  v_lshlrev_b32 v136, 16, v128
  v_and_b32 v137, 0xffff0000, v128
  v_lshlrev_b32 v138, 16, v129
  v_and_b32 v139, 0xffff0000, v129
  v_dot2c_f32_bf16 v132, s60, v92
  v_dot2c_f32_bf16 v133, s61, v92
  v_dot2c_f32_bf16 v134, s60, v93
  v_dot2c_f32_bf16 v135, s61, v93
  v_dot2c_f32_bf16 v136, s60, v94
  v_dot2c_f32_bf16 v137, s61, v94
  v_dot2c_f32_bf16 v138, s60, v95
  v_dot2c_f32_bf16 v139, s61, v95
  v_dot2c_f32_bf16 v132, s60, v96
  v_dot2c_f32_bf16 v133, s61, v96
  v_dot2c_f32_bf16 v134, s60, v97
  v_dot2c_f32_bf16 v135, s61, v97
  v_dot2c_f32_bf16 v136, s60, v98
  v_dot2c_f32_bf16 v137, s61, v98
  v_dot2c_f32_bf16 v138, s60, v99
  v_dot2c_f32_bf16 v139, s61, v99
  v_dot2c_f32_bf16 v132, s60, v100
  v_dot2c_f32_bf16 v133, s61, v100
  v_dot2c_f32_bf16 v134, s60, v101
  v_dot2c_f32_bf16 v135, s61, v101
  v_dot2c_f32_bf16 v136, s60, v102
  v_dot2c_f32_bf16 v137, s61, v102
  v_dot2c_f32_bf16 v138, s60, v103
  v_dot2c_f32_bf16 v139, s61, v103
  v_dot2c_f32_bf16 v132, s60, v104
  v_dot2c_f32_bf16 v133, s61, v104
  v_dot2c_f32_bf16 v134, s60, v105
  v_dot2c_f32_bf16 v135, s61, v105
  v_dot2c_f32_bf16 v136, s60, v106
  v_dot2c_f32_bf16 v137, s61, v106
  v_dot2c_f32_bf16 v138, s60, v107
  v_dot2c_f32_bf16 v139, s61, v107
  v_dot2c_f32_bf16 v132, s60, v108
  v_dot2c_f32_bf16 v133, s61, v108
  v_dot2c_f32_bf16 v134, s60, v109
  v_dot2c_f32_bf16 v135, s61, v109
  v_dot2c_f32_bf16 v136, s60, v110
  v_dot2c_f32_bf16 v137, s61, v110
  v_dot2c_f32_bf16 v138, s60, v111
  v_dot2c_f32_bf16 v139, s61, v111
  v_dot2c_f32_bf16 v132, s60, v112
  v_dot2c_f32_bf16 v133, s61, v112
  v_dot2c_f32_bf16 v134, s60, v113
  v_dot2c_f32_bf16 v135, s61, v113
  v_dot2c_f32_bf16 v136, s60, v114
  v_dot2c_f32_bf16 v137, s61, v114
  v_dot2c_f32_bf16 v138, s60, v115
  v_dot2c_f32_bf16 v139, s61, v115
  v_dot2c_f32_bf16 v132, s60, v116
  v_dot2c_f32_bf16 v133, s61, v116
  v_dot2c_f32_bf16 v134, s60, v117
  v_dot2c_f32_bf16 v135, s61, v117
  v_dot2c_f32_bf16 v136, s60, v118
  v_dot2c_f32_bf16 v137, s61, v118
  v_dot2c_f32_bf16 v138, s60, v119
  v_dot2c_f32_bf16 v139, s61, v119
  v_dot2c_f32_bf16 v132, s60, v120
  v_dot2c_f32_bf16 v133, s61, v120
  v_dot2c_f32_bf16 v134, s60, v121
  v_dot2c_f32_bf16 v135, s61, v121
  v_dot2c_f32_bf16 v136, s60, v122
  v_dot2c_f32_bf16 v137, s61, v122
  v_dot2c_f32_bf16 v138, s60, v123
  v_dot2c_f32_bf16 v139, s61, v123
  v_dot2c_f32_bf16 v132, s60, v124
  v_dot2c_f32_bf16 v133, s61, v124
  v_dot2c_f32_bf16 v134, s60, v125
  v_dot2c_f32_bf16 v135, s61, v125
  v_dot2c_f32_bf16 v136, s60, v126
  v_dot2c_f32_bf16 v137, s61, v126
  v_dot2c_f32_bf16 v138, s60, v127
  v_dot2c_f32_bf16 v139, s61, v127
  s_nop 2
  v_cvt_pk_bf16_f32 v140, v132, v133
  v_cvt_pk_bf16_f32 v141, v134, v135
  v_cvt_pk_bf16_f32 v142, v136, v137
  v_cvt_pk_bf16_f32 v143, v138, v139
  s_add_u32 s54, s48, 0
  s_mul_i32 s54, s54, 18432
  s_add_u32 s51, s44, 2
  s_lshl_b32 s51, s51, 5
  s_add_u32 s54, s54, s51
  buffer_store_dwordx2 v[140:141], v7, s[16:19], s54 offen
  s_add_u32 s54, s48, 1
  s_mul_i32 s54, s54, 18432
  s_add_u32 s51, s44, 2
  s_lshl_b32 s51, s51, 5
  s_add_u32 s54, s54, s51
  buffer_store_dwordx2 v[142:143], v7, s[16:19], s54 offen
  s_nop 1
red_kernel_end:
  s_endpgm
L_text_end:
.section .rodata,"a"
.p2align 6
.amdhsa_kernel p1_kernel
  .amdhsa_next_free_vgpr 256
  .amdhsa_next_free_sgpr 102
  .amdhsa_accum_offset 256
  .amdhsa_group_segment_fixed_size 0
  .amdhsa_kernarg_size 96
  .amdhsa_user_sgpr_count 2
  .amdhsa_user_sgpr_kernarg_segment_ptr 1
  .amdhsa_system_sgpr_workgroup_id_x 1
  .amdhsa_float_denorm_mode_32 3
.end_amdhsa_kernel
.p2align 6
.amdhsa_kernel p2_kernel
  .amdhsa_next_free_vgpr 512
  .amdhsa_next_free_sgpr 102
  .amdhsa_accum_offset 256
  .amdhsa_group_segment_fixed_size 0
  .amdhsa_kernarg_size 96
  .amdhsa_user_sgpr_count 2
  .amdhsa_user_sgpr_kernarg_segment_ptr 1
  .amdhsa_system_sgpr_workgroup_id_x 1
  .amdhsa_float_denorm_mode_32 3
.end_amdhsa_kernel
.p2align 6
.amdhsa_kernel ffn_kernel
  .amdhsa_next_free_vgpr 512
  .amdhsa_next_free_sgpr 102
  .amdhsa_accum_offset 256
  .amdhsa_group_segment_fixed_size 0
  .amdhsa_kernarg_size 96
  .amdhsa_user_sgpr_count 2
  .amdhsa_user_sgpr_kernarg_segment_ptr 1
  .amdhsa_system_sgpr_workgroup_id_x 1
  .amdhsa_float_denorm_mode_32 3
.end_amdhsa_kernel
.p2align 6
.amdhsa_kernel red_kernel
  .amdhsa_next_free_vgpr 152
  .amdhsa_next_free_sgpr 102
  .amdhsa_accum_offset 152
  .amdhsa_group_segment_fixed_size 0
  .amdhsa_kernarg_size 96
  .amdhsa_user_sgpr_count 2
  .amdhsa_user_sgpr_kernarg_segment_ptr 1
  .amdhsa_system_sgpr_workgroup_id_x 1
  .amdhsa_float_denorm_mode_32 3
.end_amdhsa_kernel
```
